```python
import torch

def _softmax(x, axis=-1):
    return torch.softmax(x, dim=axis)

def _gelu(x):
    return torch.nn.functional.gelu(x, approximate='tanh')

def _silu(x):
    return torch.nn.functional.silu(x)

def _sigmoid(x):
    return torch.sigmoid(x)

def _layernorm(x, axis=-1, eps=1e-05):
    m = x.mean(dim=axis, keepdim=True)
    v = x.var(dim=axis, keepdim=True, unbiased=False)
    return (x - m) / torch.sqrt(v + eps)

def _scatter_add(tgt, idx, src, axis=0):
    return tgt.clone().index_add_(axis, idx, src)

def _segment_sum(src, seg, n):
    out = torch.zeros((n,) + src.shape[1:], dtype=src.dtype)
    return out.index_add_(0, seg, src)

def _pad(x, pw):
    flat = tuple((v for pair in reversed(pw) for v in pair))
    return torch.nn.functional.pad(x, flat)
kernel_name = 'standalone__tree_speculative_verify_tree_attention_over_candidate_token_tree__decode'

def setup_inputs():

    _w = lambda a: (lambda t: t.to(torch.bfloat16) if t.is_floating_point() else t)(torch.as_tensor(a))
    B, Hq, Hkv, T, C, D = (1, 32, 16, 1, 65536, 128)
    tree_mask = torch.zeros((B, T, T), dtype=float)
    for b in range(B):
        parent = torch.zeros(T, dtype=torch.int64)
        for i in range(1, T):
            parent[i] = int(torch.randint(0, i, (1,)).item())
        for i in range(T):
            j = i
            tree_mask[b, i, j] = 1.0
            while j > 0:
                j = parent[j]
                tree_mask[b, i, j] = 1.0
    return {'q': _w((lambda *s: torch.randn(*s, dtype=torch.bfloat16) * 0.8)(B, Hq, T, D)), 'k_cache': _w((lambda *s: torch.randn(*s, dtype=torch.bfloat16) * 0.8)(B, Hkv, C, D)), 'v_cache': _w((lambda *s: torch.randn(*s, dtype=torch.bfloat16) * 0.05)(B, Hkv, C, D)), 'k_tree': _w((lambda *s: torch.randn(*s, dtype=torch.bfloat16) * 0.8)(B, Hkv, T, D)), 'v_tree': _w((lambda *s: torch.randn(*s, dtype=torch.bfloat16) * 0.05)(B, Hkv, T, D)), 'tree_mask': _w(tree_mask)}

def reference(q, k_cache, v_cache, k_tree, v_tree, tree_mask):
    B, Hq, T, D = q.shape
    Hkv, C = (k_cache.shape[1], k_cache.shape[2])
    rep = Hq // Hkv
    kc = (lambda x, n, axis: torch.repeat_interleave(x, n, dim=axis))(k_cache, rep, axis=1)
    vc = (lambda x, n, axis: torch.repeat_interleave(x, n, dim=axis))(v_cache, rep, axis=1)
    kt = (lambda x, n, axis: torch.repeat_interleave(x, n, dim=axis))(k_tree, rep, axis=1)
    vt = (lambda x, n, axis: torch.repeat_interleave(x, n, dim=axis))(v_tree, rep, axis=1)
    k = torch.concatenate([kc, kt], axis=2)
    v = torch.concatenate([vc, vt], axis=2)
    scale = D ** (-0.5)
    scores = torch.einsum('bhqd,bhkd->bhqk', q, k) * scale
    ctx_mask = torch.ones((B, 1, T, C), dtype=scores.dtype)
    tm = tree_mask[:, None, :, :].clone()
    full_mask = torch.concatenate([ctx_mask, tm], axis=-1)
    scores = scores + (1.0 - full_mask) * -1000000000.0
    p = _softmax(scores, axis=-1)
    return torch.einsum('bhqk,bhkd->bhqd', p, v)
```

```asm
; @launch grid=(272,1,1) block=(64,1,1) lds=32768
.amdgcn_target "amdgcn-amd-amdhsa--gfx950"
.text
.globl standalone__tree_speculative_verify_tree_attention_over_candidate_token_tree__decode_kernel
.p2align 8
.type standalone__tree_speculative_verify_tree_attention_over_candidate_token_tree__decode_kernel,@function
standalone__tree_speculative_verify_tree_attention_over_candidate_token_tree__decode_kernel:
    s_cmp_ge_u32 s2, 256
    s_cbranch_scc1 L_comb
    s_load_dwordx4 s[28:31], s[0:1], 0
    s_load_dwordx8 s[36:43], s[0:1], 16
    s_load_dwordx4 s[44:47], s[0:1], 56
    s_getpc_b64 s[50:51]
L_pc:
    v_lshlrev_b32 v22, 7, v0
    v_min_u32 v3, L_end-L_pc, v22
    global_load_dword v66, v3, s[50:51]
    v_add_u32 v22, 0x2000, v22
    v_min_u32 v3, L_end-L_pc, v22
    global_load_dword v66, v3, s[50:51]
    s_mov_b32 s24, 0
    s_bitcmp1_b32 s2, 0
    s_cselect_b32 s4, 0x101100, 0
    s_xor_b32 s24, s24, s4
    s_bitcmp1_b32 s2, 1
    s_cselect_b32 s4, 0x400, 0
    s_xor_b32 s24, s24, s4
    s_bitcmp1_b32 s2, 2
    s_cselect_b32 s4, 0xc00, 0
    s_xor_b32 s24, s24, s4
    s_bitcmp1_b32 s2, 3
    s_cselect_b32 s4, 0x200, 0
    s_xor_b32 s24, s24, s4
    s_bitcmp1_b32 s2, 4
    s_cselect_b32 s4, 0x8001100, 0
    s_xor_b32 s24, s24, s4
    s_bitcmp1_b32 s2, 5
    s_cselect_b32 s4, 0x1000500, 0
    s_xor_b32 s24, s24, s4
    s_bitcmp1_b32 s2, 6
    s_cselect_b32 s4, 0x2000800, 0
    s_xor_b32 s24, s24, s4
    s_bitcmp1_b32 s2, 7
    s_cselect_b32 s4, 0x4004500, 0
    s_xor_b32 s24, s24, s4
    s_and_b32 s3, s2, 15
    s_cselect_b32 s14, 0, 256
    s_cselect_b32 s7, 0, 1.0
    s_lshr_b32 s19, s24, 24
    v_lshlrev_b32 v2, 4, v0
    v_and_b32 v3, 3, v0
    v_lshrrev_b32 v22, 4, v0
    v_lshlrev_b32 v3, 4, v3
    v_lshl_or_b32 v3, v22, 6, v3
    v_bfe_i32 v22, v0, 2, 1
    v_bfe_i32 v23, v0, 3, 1
    v_and_b32 v22, 0x4800, v22
    v_and_b32 v24, 0xa300, v23
    v_xor_b32 v1, v22, v3
    v_xor_b32 v1, v24, v1
    v_xor_b32 v61, s24, v1
    v_and_b32 v22, 0x100, v23
    v_or_b32 v22, v22, v3
    v_mov_b32 v56, 0
    s_mov_b32 s10, 268435456
    s_mov_b32 s11, 0x20000
    s_mov_b32 s15, 0x20000
    s_lshl_b32 s4, s19, 4
    s_or_b32 s4, s4, s3
    s_lshl_b32 s4, s4, 10
    v_add_u32 v58, s4, v2
    v_mov_b32 v16, 0xffa5a5a5
    v_mov_b32 v17, v16
    v_mov_b32 v18, v16
    v_mov_b32 v19, v16
    s_mov_b32 s22, 266240
    s_mov_b32 s23, 0x20000
    s_lshl_b32 s4, s19, 9
    s_lshl_b32 s5, s19, 8
    s_waitcnt lgkmcnt(0)
    s_mov_b32 s8, s30
    s_mov_b32 s9, s31
    buffer_load_dwordx4 v[68:71], v61, s[8:11], 0 offen nt
    v_xor_b32 v65, 0x5100, v61
    buffer_load_dwordx4 v[72:75], v65, s[8:11], 0 offen nt
    v_xor_b32 v64, 0x10200, v61
    buffer_load_dwordx4 v[76:79], v64, s[8:11], 0 offen nt
    v_xor_b32 v65, 0x15300, v61
    buffer_load_dwordx4 v[80:83], v65, s[8:11], 0 offen nt
    s_add_u32 s28, s28, s4
    s_addc_u32 s29, s29, 0
    s_add_u32 s38, s38, s5
    s_addc_u32 s39, s39, 0
    s_add_u32 s12, s40, s5
    s_addc_u32 s13, s41, 0
    global_load_dwordx4 v[4:7], v22, s[28:29]
    global_load_dwordx4 v[40:43], v3, s[38:39]
    global_load_ushort v35, v56, s[42:43]
    buffer_load_dwordx4 v[52:55], v2, s[12:15], 0 offen
    v_xor_b32 v64, 0x202200, v61
    buffer_load_dwordx4 v[84:87], v64, s[8:11], 0 offen nt
    v_xor_b32 v65, 0x207300, v61
    buffer_load_dwordx4 v[88:91], v65, s[8:11], 0 offen nt
    v_xor_b32 v64, 0x212000, v61
    buffer_load_dwordx4 v[92:95], v64, s[8:11], 0 offen nt
    v_xor_b32 v65, 0x217100, v61
    buffer_load_dwordx4 v[96:99], v65, s[8:11], 0 offen nt
    v_xor_b32 v64, 0x20400, v61
    buffer_load_dwordx4 v[100:103], v64, s[8:11], 0 offen nt
    v_xor_b32 v65, 0x25500, v61
    buffer_load_dwordx4 v[104:107], v65, s[8:11], 0 offen nt
    v_xor_b32 v64, 0x30600, v61
    buffer_load_dwordx4 v[108:111], v64, s[8:11], 0 offen nt
    v_xor_b32 v65, 0x35700, v61
    buffer_load_dwordx4 v[112:115], v65, s[8:11], 0 offen nt
    v_xor_b32 v64, 0x222600, v61
    buffer_load_dwordx4 v[116:119], v64, s[8:11], 0 offen nt
    v_xor_b32 v65, 0x227700, v61
    buffer_load_dwordx4 v[120:123], v65, s[8:11], 0 offen nt
    v_xor_b32 v64, 0x232400, v61
    buffer_load_dwordx4 v[124:127], v64, s[8:11], 0 offen nt
    v_xor_b32 v65, 0x237500, v61
    buffer_load_dwordx4 v[128:131], v65, s[8:11], 0 offen nt
    s_mov_b32 s20, s46
    s_mov_b32 s21, s47
    buffer_store_dwordx4 v[16:19], v58, s[20:23], 0 offen sc1
    v_xor_b32 v64, 0x100, v61
    buffer_load_dwordx4 v[132:135], v64, s[8:11], 0 offen nt
    v_xor_b32 v65, 0x5000, v61
    buffer_load_dwordx4 v[136:139], v65, s[8:11], 0 offen nt
    v_xor_b32 v64, 0x10300, v61
    buffer_load_dwordx4 v[140:143], v64, s[8:11], 0 offen nt
    v_xor_b32 v65, 0x15200, v61
    buffer_load_dwordx4 v[144:147], v65, s[8:11], 0 offen nt
    v_xor_b32 v64, 0x202300, v61
    buffer_load_dwordx4 v[148:151], v64, s[8:11], 0 offen nt
    v_xor_b32 v65, 0x207200, v61
    buffer_load_dwordx4 v[152:155], v65, s[8:11], 0 offen nt
    v_xor_b32 v64, 0x212100, v61
    buffer_load_dwordx4 v[156:159], v64, s[8:11], 0 offen nt
    v_xor_b32 v65, 0x217000, v61
    buffer_load_dwordx4 v[160:163], v65, s[8:11], 0 offen nt
    v_xor_b32 v64, 0x20500, v61
    buffer_load_dwordx4 v[164:167], v64, s[8:11], 0 offen nt
    v_xor_b32 v65, 0x25400, v61
    buffer_load_dwordx4 v[168:171], v65, s[8:11], 0 offen nt
    v_xor_b32 v64, 0x30700, v61
    buffer_load_dwordx4 v[172:175], v64, s[8:11], 0 offen nt
    v_xor_b32 v65, 0x35600, v61
    buffer_load_dwordx4 v[176:179], v65, s[8:11], 0 offen nt
    v_xor_b32 v64, 0x222700, v61
    buffer_load_dwordx4 v[180:183], v64, s[8:11], 0 offen nt
    v_xor_b32 v65, 0x227600, v61
    buffer_load_dwordx4 v[184:187], v65, s[8:11], 0 offen nt
    v_xor_b32 v64, 0x232500, v61
    buffer_load_dwordx4 v[188:191], v64, s[8:11], 0 offen nt
    v_xor_b32 v65, 0x237400, v61
    buffer_load_dwordx4 v[192:195], v65, s[8:11], 0 offen nt
    s_mov_b32 s26, 0
    v_and_b32 v24, 0xff, v2
    v_mov_b32 v59, s24
    v_bfe_i32 v3, v0, 0, 1
    v_and_b32 v3, 0x901300, v3
    v_xor_b32 v59, v59, v3
    v_bfe_i32 v3, v0, 1, 1
    v_and_b32 v3, 0x484500, v3
    v_xor_b32 v59, v59, v3
    v_bfe_i32 v3, v0, 2, 1
    v_and_b32 v3, 0x2200, v3
    v_xor_b32 v59, v59, v3
    v_bfe_i32 v3, v0, 3, 1
    v_and_b32 v3, 0x84600, v3
    v_xor_b32 v59, v59, v3
    v_bfe_i32 v3, v0, 4, 1
    v_and_b32 v3, 0x40800, v3
    v_xor_b32 v59, v59, v3
    v_bfe_i32 v3, v0, 4, 1
    v_bfe_i32 v22, v0, 5, 1
    v_and_b32 v3, 0x4800, v3
    v_and_b32 v22, 0xa300, v22
    v_xor_b32 v60, v3, v24
    v_xor_b32 v60, v22, v60
    v_and_b32 v3, 1, v0
    v_mov_b32 v22, 0xffff
    v_lshlrev_b32 v3, 4, v3
    v_lshlrev_b32 v22, v3, v22
    v_bfe_u32 v3, v0, 1, 2
    v_and_b32 v24, 3, v0
    v_cmp_eq_u32 vcc, 0, v3
    v_cmp_eq_u32 s[16:17], 0, v24
    s_nop 0
    v_cndmask_b32 v12, 0, v22, vcc
    v_cmp_eq_u32 vcc, 1, v3
    v_cmp_eq_u32 s[28:29], 1, v24
    s_nop 0
    v_cndmask_b32 v13, 0, v22, vcc
    v_cmp_eq_u32 vcc, 2, v3
    v_cmp_eq_u32 s[30:31], 2, v24
    s_nop 0
    v_cndmask_b32 v14, 0, v22, vcc
    v_cmp_eq_u32 vcc, 3, v3
    v_cmp_eq_u32 s[38:39], 3, v24
    s_nop 0
    v_cndmask_b32 v15, 0, v22, vcc
    v_mov_b32 v25, 0x3e0293ee
    v_and_b32 v3, 0x37, v0
    v_cmp_eq_u32 vcc, 0, v3
    v_mov_b32 v22, s7
    v_and_b32 v57, 8, v23
    v_cndmask_b32 v21, 0, v22, vcc
    v_bfe_i32 v23, v0, 2, 1
    v_lshlrev_b32 v34, 3, v0
    s_lshl_b32 s4, s19, 2
    s_add_u32 s44, s44, s4
    s_addc_u32 s45, s45, 0
    s_lshl_b32 s4, s3, 4
    s_add_u32 s4, s4, s5
    s_add_u32 s4, s4, 262144
    v_add_u32 v57, s4, v57
    s_waitcnt vmcnt(30)
    v_mfma_f32_16x16x32_bf16 v[36:39], v[40:43], v[4:7], 0
    v_and_b32 v8, v23, v4
    v_and_b32 v9, v23, v5
    v_and_b32 v10, v23, v6
    v_and_b32 v11, v23, v7
    v_xor_b32 v4, v8, v4
    v_xor_b32 v5, v9, v5
    v_xor_b32 v6, v10, v6
    v_xor_b32 v7, v11, v7
    v_lshlrev_b32 v35, 16, v35
    v_sub_f32 v35, 1.0, v35
    v_mul_f32 v35, 0xceabfb8f, v35
    s_nop 1
    v_fmac_f32_dpp v35, v36, v25 quad_perm:[0,0,0,0] row_mask:0xf bank_mask:0xf
    s_nop 1
    v_fmac_f32_dpp v35, v37, v25 quad_perm:[1,1,1,1] row_mask:0xf bank_mask:0xf
    s_nop 1
    v_fmac_f32_dpp v35, v38, v25 quad_perm:[2,2,2,2] row_mask:0xf bank_mask:0xf
    s_nop 1
    v_fmac_f32_dpp v35, v39, v25 quad_perm:[3,3,3,3] row_mask:0xf bank_mask:0xf
    v_mov_b32 v20, v35
L_kloop:
    s_add_u32 s26, s26, 1
    s_cmp_eq_u32 s26, 32
    s_cbranch_scc1 L_switch
L_kbody:
    v_readlane_b32 s25, v59, s26
    s_nop 1
    v_xor_b32 v61, s25, v1
    s_waitcnt vmcnt(24)
    v_mfma_f32_16x16x32_bf16 v[36:39], v[68:71], v[4:7], 0
    buffer_load_dwordx4 v[68:71], v61, s[8:11], 0 offen nt
    v_xor_b32 v65, 0x5100, v61
    s_waitcnt vmcnt(24)
    v_mfma_f32_16x16x32_bf16 v[36:39], v[72:75], v[8:11], v[36:39]
    buffer_load_dwordx4 v[72:75], v65, s[8:11], 0 offen nt
    v_xor_b32 v64, 0x10200, v61
    s_waitcnt vmcnt(24)
    v_mfma_f32_16x16x32_bf16 v[40:43], v[76:79], v[4:7], 0
    buffer_load_dwordx4 v[76:79], v64, s[8:11], 0 offen nt
    v_xor_b32 v65, 0x15300, v61
    s_waitcnt vmcnt(24)
    v_mfma_f32_16x16x32_bf16 v[40:43], v[80:83], v[8:11], v[40:43]
    buffer_load_dwordx4 v[80:83], v65, s[8:11], 0 offen nt
    v_mul_f32_dpp v26, v36, v25 quad_perm:[0,0,0,0] row_mask:0xf bank_mask:0xf
    s_nop 1
    v_fmac_f32_dpp v26, v37, v25 quad_perm:[1,1,1,1] row_mask:0xf bank_mask:0xf
    s_nop 1
    v_fmac_f32_dpp v26, v38, v25 quad_perm:[2,2,2,2] row_mask:0xf bank_mask:0xf
    v_mul_f32_dpp v27, v40, v25 quad_perm:[0,0,0,0] row_mask:0xf bank_mask:0xf
    s_nop 0
    v_fmac_f32_dpp v26, v39, v25 quad_perm:[3,3,3,3] row_mask:0xf bank_mask:0xf
    v_fmac_f32_dpp v27, v41, v25 quad_perm:[1,1,1,1] row_mask:0xf bank_mask:0xf
    v_cndmask_b32 v28, v28, v26, s[16:17]
    s_nop 0
    v_fmac_f32_dpp v27, v42, v25 quad_perm:[2,2,2,2] row_mask:0xf bank_mask:0xf
    s_nop 1
    v_fmac_f32_dpp v27, v43, v25 quad_perm:[3,3,3,3] row_mask:0xf bank_mask:0xf
    v_cndmask_b32 v29, v29, v27, s[16:17]
    v_xor_b32 v64, 0x202200, v61
    s_waitcnt vmcnt(24)
    v_mfma_f32_16x16x32_bf16 v[36:39], v[84:87], v[4:7], 0
    buffer_load_dwordx4 v[84:87], v64, s[8:11], 0 offen nt
    v_xor_b32 v65, 0x207300, v61
    s_waitcnt vmcnt(24)
    v_mfma_f32_16x16x32_bf16 v[36:39], v[88:91], v[8:11], v[36:39]
    buffer_load_dwordx4 v[88:91], v65, s[8:11], 0 offen nt
    v_xor_b32 v64, 0x212000, v61
    s_waitcnt vmcnt(24)
    v_mfma_f32_16x16x32_bf16 v[40:43], v[92:95], v[4:7], 0
    buffer_load_dwordx4 v[92:95], v64, s[8:11], 0 offen nt
    v_xor_b32 v65, 0x217100, v61
    s_waitcnt vmcnt(24)
    v_mfma_f32_16x16x32_bf16 v[40:43], v[96:99], v[8:11], v[40:43]
    buffer_load_dwordx4 v[96:99], v65, s[8:11], 0 offen nt
    v_mul_f32_dpp v26, v36, v25 quad_perm:[0,0,0,0] row_mask:0xf bank_mask:0xf
    s_nop 1
    v_fmac_f32_dpp v26, v37, v25 quad_perm:[1,1,1,1] row_mask:0xf bank_mask:0xf
    s_nop 1
    v_fmac_f32_dpp v26, v38, v25 quad_perm:[2,2,2,2] row_mask:0xf bank_mask:0xf
    v_mul_f32_dpp v27, v40, v25 quad_perm:[0,0,0,0] row_mask:0xf bank_mask:0xf
    s_nop 0
    v_fmac_f32_dpp v26, v39, v25 quad_perm:[3,3,3,3] row_mask:0xf bank_mask:0xf
    v_fmac_f32_dpp v27, v41, v25 quad_perm:[1,1,1,1] row_mask:0xf bank_mask:0xf
    v_cndmask_b32 v28, v28, v26, s[28:29]
    s_nop 0
    v_fmac_f32_dpp v27, v42, v25 quad_perm:[2,2,2,2] row_mask:0xf bank_mask:0xf
    s_nop 1
    v_fmac_f32_dpp v27, v43, v25 quad_perm:[3,3,3,3] row_mask:0xf bank_mask:0xf
    v_cndmask_b32 v29, v29, v27, s[28:29]
    v_xor_b32 v64, 0x20400, v61
    s_waitcnt vmcnt(24)
    v_mfma_f32_16x16x32_bf16 v[36:39], v[100:103], v[4:7], 0
    buffer_load_dwordx4 v[100:103], v64, s[8:11], 0 offen nt
    v_xor_b32 v65, 0x25500, v61
    s_waitcnt vmcnt(24)
    v_mfma_f32_16x16x32_bf16 v[36:39], v[104:107], v[8:11], v[36:39]
    buffer_load_dwordx4 v[104:107], v65, s[8:11], 0 offen nt
    v_xor_b32 v64, 0x30600, v61
    s_waitcnt vmcnt(24)
    v_mfma_f32_16x16x32_bf16 v[40:43], v[108:111], v[4:7], 0
    buffer_load_dwordx4 v[108:111], v64, s[8:11], 0 offen nt
    v_xor_b32 v65, 0x35700, v61
    s_waitcnt vmcnt(24)
    v_mfma_f32_16x16x32_bf16 v[40:43], v[112:115], v[8:11], v[40:43]
    buffer_load_dwordx4 v[112:115], v65, s[8:11], 0 offen nt
    v_mul_f32_dpp v26, v36, v25 quad_perm:[0,0,0,0] row_mask:0xf bank_mask:0xf
    s_nop 1
    v_fmac_f32_dpp v26, v37, v25 quad_perm:[1,1,1,1] row_mask:0xf bank_mask:0xf
    s_nop 1
    v_fmac_f32_dpp v26, v38, v25 quad_perm:[2,2,2,2] row_mask:0xf bank_mask:0xf
    v_mul_f32_dpp v27, v40, v25 quad_perm:[0,0,0,0] row_mask:0xf bank_mask:0xf
    s_nop 0
    v_fmac_f32_dpp v26, v39, v25 quad_perm:[3,3,3,3] row_mask:0xf bank_mask:0xf
    v_fmac_f32_dpp v27, v41, v25 quad_perm:[1,1,1,1] row_mask:0xf bank_mask:0xf
    v_cndmask_b32 v28, v28, v26, s[30:31]
    s_nop 0
    v_fmac_f32_dpp v27, v42, v25 quad_perm:[2,2,2,2] row_mask:0xf bank_mask:0xf
    s_nop 1
    v_fmac_f32_dpp v27, v43, v25 quad_perm:[3,3,3,3] row_mask:0xf bank_mask:0xf
    v_cndmask_b32 v29, v29, v27, s[30:31]
    v_xor_b32 v64, 0x222600, v61
    s_waitcnt vmcnt(24)
    v_mfma_f32_16x16x32_bf16 v[36:39], v[116:119], v[4:7], 0
    buffer_load_dwordx4 v[116:119], v64, s[8:11], 0 offen nt
    v_xor_b32 v65, 0x227700, v61
    s_waitcnt vmcnt(24)
    v_mfma_f32_16x16x32_bf16 v[36:39], v[120:123], v[8:11], v[36:39]
    buffer_load_dwordx4 v[120:123], v65, s[8:11], 0 offen nt
    v_xor_b32 v64, 0x232400, v61
    s_waitcnt vmcnt(24)
    v_mfma_f32_16x16x32_bf16 v[40:43], v[124:127], v[4:7], 0
    buffer_load_dwordx4 v[124:127], v64, s[8:11], 0 offen nt
    v_xor_b32 v65, 0x237500, v61
    s_waitcnt vmcnt(24)
    v_mfma_f32_16x16x32_bf16 v[40:43], v[128:131], v[8:11], v[40:43]
    buffer_load_dwordx4 v[128:131], v65, s[8:11], 0 offen nt
    v_mul_f32_dpp v26, v36, v25 quad_perm:[0,0,0,0] row_mask:0xf bank_mask:0xf
    s_nop 1
    v_fmac_f32_dpp v26, v37, v25 quad_perm:[1,1,1,1] row_mask:0xf bank_mask:0xf
    s_nop 1
    v_fmac_f32_dpp v26, v38, v25 quad_perm:[2,2,2,2] row_mask:0xf bank_mask:0xf
    v_mul_f32_dpp v27, v40, v25 quad_perm:[0,0,0,0] row_mask:0xf bank_mask:0xf
    s_nop 0
    v_fmac_f32_dpp v26, v39, v25 quad_perm:[3,3,3,3] row_mask:0xf bank_mask:0xf
    v_fmac_f32_dpp v27, v41, v25 quad_perm:[1,1,1,1] row_mask:0xf bank_mask:0xf
    v_cndmask_b32 v28, v28, v26, s[38:39]
    s_nop 0
    v_fmac_f32_dpp v27, v42, v25 quad_perm:[2,2,2,2] row_mask:0xf bank_mask:0xf
    s_nop 1
    v_fmac_f32_dpp v27, v43, v25 quad_perm:[3,3,3,3] row_mask:0xf bank_mask:0xf
    v_cndmask_b32 v29, v29, v27, s[38:39]
    ds_write_b64 v34, v[28:29] offset:0
    v_max3_f32 v20, v20, v28, v29
    v_xor_b32 v64, 0x100, v61
    s_waitcnt vmcnt(24)
    v_mfma_f32_16x16x32_bf16 v[36:39], v[132:135], v[4:7], 0
    buffer_load_dwordx4 v[132:135], v64, s[8:11], 0 offen nt
    v_xor_b32 v65, 0x5000, v61
    s_waitcnt vmcnt(24)
    v_mfma_f32_16x16x32_bf16 v[36:39], v[136:139], v[8:11], v[36:39]
    buffer_load_dwordx4 v[136:139], v65, s[8:11], 0 offen nt
    v_xor_b32 v64, 0x10300, v61
    s_waitcnt vmcnt(24)
    v_mfma_f32_16x16x32_bf16 v[40:43], v[140:143], v[4:7], 0
    buffer_load_dwordx4 v[140:143], v64, s[8:11], 0 offen nt
    v_xor_b32 v65, 0x15200, v61
    s_waitcnt vmcnt(24)
    v_mfma_f32_16x16x32_bf16 v[40:43], v[144:147], v[8:11], v[40:43]
    buffer_load_dwordx4 v[144:147], v65, s[8:11], 0 offen nt
    v_mul_f32_dpp v26, v36, v25 quad_perm:[0,0,0,0] row_mask:0xf bank_mask:0xf
    s_nop 1
    v_fmac_f32_dpp v26, v37, v25 quad_perm:[1,1,1,1] row_mask:0xf bank_mask:0xf
    s_nop 1
    v_fmac_f32_dpp v26, v38, v25 quad_perm:[2,2,2,2] row_mask:0xf bank_mask:0xf
    v_mul_f32_dpp v27, v40, v25 quad_perm:[0,0,0,0] row_mask:0xf bank_mask:0xf
    s_nop 0
    v_fmac_f32_dpp v26, v39, v25 quad_perm:[3,3,3,3] row_mask:0xf bank_mask:0xf
    v_fmac_f32_dpp v27, v41, v25 quad_perm:[1,1,1,1] row_mask:0xf bank_mask:0xf
    v_cndmask_b32 v28, v28, v26, s[16:17]
    s_nop 0
    v_fmac_f32_dpp v27, v42, v25 quad_perm:[2,2,2,2] row_mask:0xf bank_mask:0xf
    s_nop 1
    v_fmac_f32_dpp v27, v43, v25 quad_perm:[3,3,3,3] row_mask:0xf bank_mask:0xf
    v_cndmask_b32 v29, v29, v27, s[16:17]
    v_xor_b32 v64, 0x202300, v61
    s_waitcnt vmcnt(24)
    v_mfma_f32_16x16x32_bf16 v[36:39], v[148:151], v[4:7], 0
    buffer_load_dwordx4 v[148:151], v64, s[8:11], 0 offen nt
    v_xor_b32 v65, 0x207200, v61
    s_waitcnt vmcnt(24)
    v_mfma_f32_16x16x32_bf16 v[36:39], v[152:155], v[8:11], v[36:39]
    buffer_load_dwordx4 v[152:155], v65, s[8:11], 0 offen nt
    v_xor_b32 v64, 0x212100, v61
    s_waitcnt vmcnt(24)
    v_mfma_f32_16x16x32_bf16 v[40:43], v[156:159], v[4:7], 0
    buffer_load_dwordx4 v[156:159], v64, s[8:11], 0 offen nt
    v_xor_b32 v65, 0x217000, v61
    s_waitcnt vmcnt(24)
    v_mfma_f32_16x16x32_bf16 v[40:43], v[160:163], v[8:11], v[40:43]
    buffer_load_dwordx4 v[160:163], v65, s[8:11], 0 offen nt
    v_mul_f32_dpp v26, v36, v25 quad_perm:[0,0,0,0] row_mask:0xf bank_mask:0xf
    s_nop 1
    v_fmac_f32_dpp v26, v37, v25 quad_perm:[1,1,1,1] row_mask:0xf bank_mask:0xf
    s_nop 1
    v_fmac_f32_dpp v26, v38, v25 quad_perm:[2,2,2,2] row_mask:0xf bank_mask:0xf
    v_mul_f32_dpp v27, v40, v25 quad_perm:[0,0,0,0] row_mask:0xf bank_mask:0xf
    s_nop 0
    v_fmac_f32_dpp v26, v39, v25 quad_perm:[3,3,3,3] row_mask:0xf bank_mask:0xf
    v_fmac_f32_dpp v27, v41, v25 quad_perm:[1,1,1,1] row_mask:0xf bank_mask:0xf
    v_cndmask_b32 v28, v28, v26, s[28:29]
    s_nop 0
    v_fmac_f32_dpp v27, v42, v25 quad_perm:[2,2,2,2] row_mask:0xf bank_mask:0xf
    s_nop 1
    v_fmac_f32_dpp v27, v43, v25 quad_perm:[3,3,3,3] row_mask:0xf bank_mask:0xf
    v_cndmask_b32 v29, v29, v27, s[28:29]
    v_xor_b32 v64, 0x20500, v61
    s_waitcnt vmcnt(24)
    v_mfma_f32_16x16x32_bf16 v[36:39], v[164:167], v[4:7], 0
    buffer_load_dwordx4 v[164:167], v64, s[8:11], 0 offen nt
    v_xor_b32 v65, 0x25400, v61
    s_waitcnt vmcnt(24)
    v_mfma_f32_16x16x32_bf16 v[36:39], v[168:171], v[8:11], v[36:39]
    buffer_load_dwordx4 v[168:171], v65, s[8:11], 0 offen nt
    v_xor_b32 v64, 0x30700, v61
    s_waitcnt vmcnt(24)
    v_mfma_f32_16x16x32_bf16 v[40:43], v[172:175], v[4:7], 0
    buffer_load_dwordx4 v[172:175], v64, s[8:11], 0 offen nt
    v_xor_b32 v65, 0x35600, v61
    s_waitcnt vmcnt(24)
    v_mfma_f32_16x16x32_bf16 v[40:43], v[176:179], v[8:11], v[40:43]
    buffer_load_dwordx4 v[176:179], v65, s[8:11], 0 offen nt
    v_mul_f32_dpp v26, v36, v25 quad_perm:[0,0,0,0] row_mask:0xf bank_mask:0xf
    s_nop 1
    v_fmac_f32_dpp v26, v37, v25 quad_perm:[1,1,1,1] row_mask:0xf bank_mask:0xf
    s_nop 1
    v_fmac_f32_dpp v26, v38, v25 quad_perm:[2,2,2,2] row_mask:0xf bank_mask:0xf
    v_mul_f32_dpp v27, v40, v25 quad_perm:[0,0,0,0] row_mask:0xf bank_mask:0xf
    s_nop 0
    v_fmac_f32_dpp v26, v39, v25 quad_perm:[3,3,3,3] row_mask:0xf bank_mask:0xf
    v_fmac_f32_dpp v27, v41, v25 quad_perm:[1,1,1,1] row_mask:0xf bank_mask:0xf
    v_cndmask_b32 v28, v28, v26, s[30:31]
    s_nop 0
    v_fmac_f32_dpp v27, v42, v25 quad_perm:[2,2,2,2] row_mask:0xf bank_mask:0xf
    s_nop 1
    v_fmac_f32_dpp v27, v43, v25 quad_perm:[3,3,3,3] row_mask:0xf bank_mask:0xf
    v_cndmask_b32 v29, v29, v27, s[30:31]
    v_xor_b32 v64, 0x222700, v61
    s_waitcnt vmcnt(24)
    v_mfma_f32_16x16x32_bf16 v[36:39], v[180:183], v[4:7], 0
    buffer_load_dwordx4 v[180:183], v64, s[8:11], 0 offen nt
    v_xor_b32 v65, 0x227600, v61
    s_waitcnt vmcnt(24)
    v_mfma_f32_16x16x32_bf16 v[36:39], v[184:187], v[8:11], v[36:39]
    buffer_load_dwordx4 v[184:187], v65, s[8:11], 0 offen nt
    v_xor_b32 v64, 0x232500, v61
    s_waitcnt vmcnt(24)
    v_mfma_f32_16x16x32_bf16 v[40:43], v[188:191], v[4:7], 0
    buffer_load_dwordx4 v[188:191], v64, s[8:11], 0 offen nt
    v_xor_b32 v65, 0x237400, v61
    s_waitcnt vmcnt(24)
    v_mfma_f32_16x16x32_bf16 v[40:43], v[192:195], v[8:11], v[40:43]
    buffer_load_dwordx4 v[192:195], v65, s[8:11], 0 offen nt
    v_mul_f32_dpp v26, v36, v25 quad_perm:[0,0,0,0] row_mask:0xf bank_mask:0xf
    s_nop 1
    v_fmac_f32_dpp v26, v37, v25 quad_perm:[1,1,1,1] row_mask:0xf bank_mask:0xf
    s_nop 1
    v_fmac_f32_dpp v26, v38, v25 quad_perm:[2,2,2,2] row_mask:0xf bank_mask:0xf
    v_mul_f32_dpp v27, v40, v25 quad_perm:[0,0,0,0] row_mask:0xf bank_mask:0xf
    s_nop 0
    v_fmac_f32_dpp v26, v39, v25 quad_perm:[3,3,3,3] row_mask:0xf bank_mask:0xf
    v_fmac_f32_dpp v27, v41, v25 quad_perm:[1,1,1,1] row_mask:0xf bank_mask:0xf
    v_cndmask_b32 v28, v28, v26, s[38:39]
    s_nop 0
    v_fmac_f32_dpp v27, v42, v25 quad_perm:[2,2,2,2] row_mask:0xf bank_mask:0xf
    s_nop 1
    v_fmac_f32_dpp v27, v43, v25 quad_perm:[3,3,3,3] row_mask:0xf bank_mask:0xf
    v_cndmask_b32 v29, v29, v27, s[38:39]
    ds_write_b64 v34, v[28:29] offset:512
    v_max3_f32 v20, v20, v28, v29
    v_add_u32 v34, 1024, v34
    s_cmp_lg_u32 s26, 0
    s_cbranch_scc1 L_kloop
    v_lshlrev_b32 v34, 3, v0
    v_max_f32_dpp v20, v20, v20 quad_perm:[1,0,3,2] row_mask:0xf bank_mask:0xf
    s_waitcnt lgkmcnt(0)
    ds_read_b64 v[28:29], v34
    v_max_f32_dpp v20, v20, v20 quad_perm:[2,3,0,1] row_mask:0xf bank_mask:0xf
    global_load_dword v56, v56, s[44:45] sc1
    s_nop 0
    v_max_f32_dpp v20, v20, v20 row_half_mirror row_mask:0xf bank_mask:0xf
    v_mov_b32 v22, v20
    s_nop 1
    v_permlane16_swap_b32 v20, v22
    v_max_f32 v20, v20, v22
    v_mov_b32 v22, v20
    s_nop 1
    v_permlane32_swap_b32 v20, v22
    v_max_f32 v20, v20, v22
    v_sub_f32 v35, v35, v20
    v_exp_f32 v35, v35
    s_nop 0
    v_cvt_pk_bf16_f32 v3, v35, v35
    v_mul_f32 v21, v21, v35
    v_and_b32 v48, v3, v12
    v_and_b32 v49, v3, v13
    v_and_b32 v50, v3, v14
    v_and_b32 v51, v3, v15
    s_nop 1
    v_mfma_f32_16x16x32_bf16 v[16:19], v[52:55], v[48:51], 0
    s_waitcnt lgkmcnt(0)
    v_sub_f32 v26, v28, v20
    v_sub_f32 v27, v29, v20
    ds_read_b64 v[28:29], v34 offset:512
    v_exp_f32 v26, v26
    v_exp_f32 v27, v27
    v_cvt_pk_bf16_f32 v30, v26, v26
    v_cvt_pk_bf16_f32 v31, v27, v27
    v_add_f32 v21, v21, v26
    v_mov_b32_dpp v32, v30 row_half_mirror row_mask:0xf bank_mask:0xf
    v_mov_b32_dpp v33, v31 row_half_mirror row_mask:0xf bank_mask:0xf
    v_add_f32 v21, v21, v27
    v_and_b32_dpp v44, v30, v12 quad_perm:[0,0,0,0] row_mask:0xf bank_mask:0xf
    v_and_b32_dpp v45, v30, v13 quad_perm:[0,0,0,0] row_mask:0xf bank_mask:0xf
    v_and_b32_dpp v46, v32, v14 quad_perm:[3,3,3,3] row_mask:0xf bank_mask:0xf
    v_and_b32_dpp v47, v32, v15 quad_perm:[3,3,3,3] row_mask:0xf bank_mask:0xf
L_vloopA:
    s_add_u32 s26, s26, 1
    v_readlane_b32 s25, v59, s26
    s_nop 1
    v_xor_b32 v61, s25, v1
    v_and_b32_dpp v50, v30, v14 quad_perm:[0,0,0,0] row_mask:0xf bank_mask:0xf
    v_and_b32_dpp v51, v30, v15 quad_perm:[0,0,0,0] row_mask:0xf bank_mask:0xf
    v_and_b32_dpp v48, v32, v12 quad_perm:[3,3,3,3] row_mask:0xf bank_mask:0xf
    v_and_b32_dpp v49, v32, v13 quad_perm:[3,3,3,3] row_mask:0xf bank_mask:0xf
    s_waitcnt vmcnt(24)
    v_mfma_f32_16x16x32_bf16 v[16:19], v[68:71], v[44:47], v[16:19]
    buffer_load_dwordx4 v[68:71], v61, s[8:11], 0 offen nt
    v_and_b32_dpp v44, v31, v12 quad_perm:[0,0,0,0] row_mask:0xf bank_mask:0xf
    v_and_b32_dpp v45, v31, v13 quad_perm:[0,0,0,0] row_mask:0xf bank_mask:0xf
    v_and_b32_dpp v46, v33, v14 quad_perm:[3,3,3,3] row_mask:0xf bank_mask:0xf
    v_and_b32_dpp v47, v33, v15 quad_perm:[3,3,3,3] row_mask:0xf bank_mask:0xf
    v_xor_b32 v65, 0x5100, v61
    s_waitcnt vmcnt(24)
    v_mfma_f32_16x16x32_bf16 v[16:19], v[72:75], v[48:51], v[16:19]
    buffer_load_dwordx4 v[72:75], v65, s[8:11], 0 offen nt
    v_and_b32_dpp v50, v31, v14 quad_perm:[0,0,0,0] row_mask:0xf bank_mask:0xf
    v_and_b32_dpp v51, v31, v15 quad_perm:[0,0,0,0] row_mask:0xf bank_mask:0xf
    v_and_b32_dpp v48, v33, v12 quad_perm:[3,3,3,3] row_mask:0xf bank_mask:0xf
    v_and_b32_dpp v49, v33, v13 quad_perm:[3,3,3,3] row_mask:0xf bank_mask:0xf
    v_xor_b32 v64, 0x10200, v61
    s_waitcnt vmcnt(24)
    v_mfma_f32_16x16x32_bf16 v[16:19], v[76:79], v[44:47], v[16:19]
    buffer_load_dwordx4 v[76:79], v64, s[8:11], 0 offen nt
    v_and_b32_dpp v44, v30, v12 quad_perm:[1,1,1,1] row_mask:0xf bank_mask:0xf
    v_and_b32_dpp v45, v30, v13 quad_perm:[1,1,1,1] row_mask:0xf bank_mask:0xf
    v_and_b32_dpp v46, v32, v14 quad_perm:[2,2,2,2] row_mask:0xf bank_mask:0xf
    v_and_b32_dpp v47, v32, v15 quad_perm:[2,2,2,2] row_mask:0xf bank_mask:0xf
    v_xor_b32 v65, 0x15300, v61
    s_waitcnt vmcnt(24)
    v_mfma_f32_16x16x32_bf16 v[16:19], v[80:83], v[48:51], v[16:19]
    buffer_load_dwordx4 v[80:83], v65, s[8:11], 0 offen nt
    v_and_b32_dpp v50, v30, v14 quad_perm:[1,1,1,1] row_mask:0xf bank_mask:0xf
    v_and_b32_dpp v51, v30, v15 quad_perm:[1,1,1,1] row_mask:0xf bank_mask:0xf
    v_and_b32_dpp v48, v32, v12 quad_perm:[2,2,2,2] row_mask:0xf bank_mask:0xf
    v_and_b32_dpp v49, v32, v13 quad_perm:[2,2,2,2] row_mask:0xf bank_mask:0xf
    v_xor_b32 v64, 0x202200, v61
    s_waitcnt vmcnt(24)
    v_mfma_f32_16x16x32_bf16 v[16:19], v[84:87], v[44:47], v[16:19]
    buffer_load_dwordx4 v[84:87], v64, s[8:11], 0 offen nt
    v_and_b32_dpp v44, v31, v12 quad_perm:[1,1,1,1] row_mask:0xf bank_mask:0xf
    v_and_b32_dpp v45, v31, v13 quad_perm:[1,1,1,1] row_mask:0xf bank_mask:0xf
    v_and_b32_dpp v46, v33, v14 quad_perm:[2,2,2,2] row_mask:0xf bank_mask:0xf
    v_and_b32_dpp v47, v33, v15 quad_perm:[2,2,2,2] row_mask:0xf bank_mask:0xf
    v_xor_b32 v65, 0x207300, v61
    s_waitcnt vmcnt(24)
    v_mfma_f32_16x16x32_bf16 v[16:19], v[88:91], v[48:51], v[16:19]
    buffer_load_dwordx4 v[88:91], v65, s[8:11], 0 offen nt
    v_and_b32_dpp v50, v31, v14 quad_perm:[1,1,1,1] row_mask:0xf bank_mask:0xf
    v_and_b32_dpp v51, v31, v15 quad_perm:[1,1,1,1] row_mask:0xf bank_mask:0xf
    v_and_b32_dpp v48, v33, v12 quad_perm:[2,2,2,2] row_mask:0xf bank_mask:0xf
    v_and_b32_dpp v49, v33, v13 quad_perm:[2,2,2,2] row_mask:0xf bank_mask:0xf
    v_xor_b32 v64, 0x212000, v61
    s_waitcnt vmcnt(24)
    v_mfma_f32_16x16x32_bf16 v[16:19], v[92:95], v[44:47], v[16:19]
    buffer_load_dwordx4 v[92:95], v64, s[8:11], 0 offen nt
    v_and_b32_dpp v44, v30, v12 quad_perm:[2,2,2,2] row_mask:0xf bank_mask:0xf
    v_and_b32_dpp v45, v30, v13 quad_perm:[2,2,2,2] row_mask:0xf bank_mask:0xf
    v_and_b32_dpp v46, v32, v14 quad_perm:[1,1,1,1] row_mask:0xf bank_mask:0xf
    v_and_b32_dpp v47, v32, v15 quad_perm:[1,1,1,1] row_mask:0xf bank_mask:0xf
    v_xor_b32 v65, 0x217100, v61
    s_waitcnt vmcnt(24)
    v_mfma_f32_16x16x32_bf16 v[16:19], v[96:99], v[48:51], v[16:19]
    buffer_load_dwordx4 v[96:99], v65, s[8:11], 0 offen nt
    v_and_b32_dpp v50, v30, v14 quad_perm:[2,2,2,2] row_mask:0xf bank_mask:0xf
    v_and_b32_dpp v51, v30, v15 quad_perm:[2,2,2,2] row_mask:0xf bank_mask:0xf
    v_and_b32_dpp v48, v32, v12 quad_perm:[1,1,1,1] row_mask:0xf bank_mask:0xf
    v_and_b32_dpp v49, v32, v13 quad_perm:[1,1,1,1] row_mask:0xf bank_mask:0xf
    v_xor_b32 v64, 0x20400, v61
    s_waitcnt vmcnt(24)
    v_mfma_f32_16x16x32_bf16 v[16:19], v[100:103], v[44:47], v[16:19]
    buffer_load_dwordx4 v[100:103], v64, s[8:11], 0 offen nt
    v_and_b32_dpp v44, v31, v12 quad_perm:[2,2,2,2] row_mask:0xf bank_mask:0xf
    v_and_b32_dpp v45, v31, v13 quad_perm:[2,2,2,2] row_mask:0xf bank_mask:0xf
    v_and_b32_dpp v46, v33, v14 quad_perm:[1,1,1,1] row_mask:0xf bank_mask:0xf
    v_and_b32_dpp v47, v33, v15 quad_perm:[1,1,1,1] row_mask:0xf bank_mask:0xf
    v_xor_b32 v65, 0x25500, v61
    s_waitcnt vmcnt(24)
    v_mfma_f32_16x16x32_bf16 v[16:19], v[104:107], v[48:51], v[16:19]
    buffer_load_dwordx4 v[104:107], v65, s[8:11], 0 offen nt
    v_and_b32_dpp v50, v31, v14 quad_perm:[2,2,2,2] row_mask:0xf bank_mask:0xf
    v_and_b32_dpp v51, v31, v15 quad_perm:[2,2,2,2] row_mask:0xf bank_mask:0xf
    v_and_b32_dpp v48, v33, v12 quad_perm:[1,1,1,1] row_mask:0xf bank_mask:0xf
    v_and_b32_dpp v49, v33, v13 quad_perm:[1,1,1,1] row_mask:0xf bank_mask:0xf
    v_xor_b32 v64, 0x30600, v61
    s_waitcnt vmcnt(24)
    v_mfma_f32_16x16x32_bf16 v[16:19], v[108:111], v[44:47], v[16:19]
    buffer_load_dwordx4 v[108:111], v64, s[8:11], 0 offen nt
    v_and_b32_dpp v44, v30, v12 quad_perm:[3,3,3,3] row_mask:0xf bank_mask:0xf
    v_and_b32_dpp v45, v30, v13 quad_perm:[3,3,3,3] row_mask:0xf bank_mask:0xf
    v_and_b32_dpp v46, v32, v14 quad_perm:[0,0,0,0] row_mask:0xf bank_mask:0xf
    v_and_b32_dpp v47, v32, v15 quad_perm:[0,0,0,0] row_mask:0xf bank_mask:0xf
    v_xor_b32 v65, 0x35700, v61
    s_waitcnt vmcnt(24)
    v_mfma_f32_16x16x32_bf16 v[16:19], v[112:115], v[48:51], v[16:19]
    buffer_load_dwordx4 v[112:115], v65, s[8:11], 0 offen nt
    v_and_b32_dpp v50, v30, v14 quad_perm:[3,3,3,3] row_mask:0xf bank_mask:0xf
    v_and_b32_dpp v51, v30, v15 quad_perm:[3,3,3,3] row_mask:0xf bank_mask:0xf
    v_and_b32_dpp v48, v32, v12 quad_perm:[0,0,0,0] row_mask:0xf bank_mask:0xf
    v_and_b32_dpp v49, v32, v13 quad_perm:[0,0,0,0] row_mask:0xf bank_mask:0xf
    v_xor_b32 v64, 0x222600, v61
    s_waitcnt vmcnt(24)
    v_mfma_f32_16x16x32_bf16 v[16:19], v[116:119], v[44:47], v[16:19]
    buffer_load_dwordx4 v[116:119], v64, s[8:11], 0 offen nt
    v_and_b32_dpp v44, v31, v12 quad_perm:[3,3,3,3] row_mask:0xf bank_mask:0xf
    v_and_b32_dpp v45, v31, v13 quad_perm:[3,3,3,3] row_mask:0xf bank_mask:0xf
    v_and_b32_dpp v46, v33, v14 quad_perm:[0,0,0,0] row_mask:0xf bank_mask:0xf
    v_and_b32_dpp v47, v33, v15 quad_perm:[0,0,0,0] row_mask:0xf bank_mask:0xf
    v_xor_b32 v65, 0x227700, v61
    s_waitcnt vmcnt(24)
    v_mfma_f32_16x16x32_bf16 v[16:19], v[120:123], v[48:51], v[16:19]
    buffer_load_dwordx4 v[120:123], v65, s[8:11], 0 offen nt
    v_and_b32_dpp v50, v31, v14 quad_perm:[3,3,3,3] row_mask:0xf bank_mask:0xf
    v_and_b32_dpp v51, v31, v15 quad_perm:[3,3,3,3] row_mask:0xf bank_mask:0xf
    v_and_b32_dpp v48, v33, v12 quad_perm:[0,0,0,0] row_mask:0xf bank_mask:0xf
    v_and_b32_dpp v49, v33, v13 quad_perm:[0,0,0,0] row_mask:0xf bank_mask:0xf
    v_xor_b32 v64, 0x232400, v61
    s_waitcnt vmcnt(24)
    v_mfma_f32_16x16x32_bf16 v[16:19], v[124:127], v[44:47], v[16:19]
    buffer_load_dwordx4 v[124:127], v64, s[8:11], 0 offen nt
    s_waitcnt lgkmcnt(0)
    v_sub_f32 v26, v28, v20
    v_sub_f32 v27, v29, v20
    ds_read_b64 v[28:29], v34 offset:1024
    v_exp_f32 v26, v26
    v_exp_f32 v27, v27
    v_cvt_pk_bf16_f32 v30, v26, v26
    v_cvt_pk_bf16_f32 v31, v27, v27
    v_add_f32 v21, v21, v26
    v_mov_b32_dpp v32, v30 row_half_mirror row_mask:0xf bank_mask:0xf
    v_mov_b32_dpp v33, v31 row_half_mirror row_mask:0xf bank_mask:0xf
    v_add_f32 v21, v21, v27
    v_and_b32_dpp v44, v30, v12 quad_perm:[0,0,0,0] row_mask:0xf bank_mask:0xf
    v_and_b32_dpp v45, v30, v13 quad_perm:[0,0,0,0] row_mask:0xf bank_mask:0xf
    v_and_b32_dpp v46, v32, v14 quad_perm:[3,3,3,3] row_mask:0xf bank_mask:0xf
    v_and_b32_dpp v47, v32, v15 quad_perm:[3,3,3,3] row_mask:0xf bank_mask:0xf
    v_xor_b32 v65, 0x237500, v61
    s_waitcnt vmcnt(24)
    v_mfma_f32_16x16x32_bf16 v[16:19], v[128:131], v[48:51], v[16:19]
    buffer_load_dwordx4 v[128:131], v65, s[8:11], 0 offen nt
    v_and_b32_dpp v50, v30, v14 quad_perm:[0,0,0,0] row_mask:0xf bank_mask:0xf
    v_and_b32_dpp v51, v30, v15 quad_perm:[0,0,0,0] row_mask:0xf bank_mask:0xf
    v_and_b32_dpp v48, v32, v12 quad_perm:[3,3,3,3] row_mask:0xf bank_mask:0xf
    v_and_b32_dpp v49, v32, v13 quad_perm:[3,3,3,3] row_mask:0xf bank_mask:0xf
    v_xor_b32 v64, 0x100, v61
    s_waitcnt vmcnt(24)
    v_mfma_f32_16x16x32_bf16 v[16:19], v[132:135], v[44:47], v[16:19]
    buffer_load_dwordx4 v[132:135], v64, s[8:11], 0 offen nt
    v_and_b32_dpp v44, v31, v12 quad_perm:[0,0,0,0] row_mask:0xf bank_mask:0xf
    v_and_b32_dpp v45, v31, v13 quad_perm:[0,0,0,0] row_mask:0xf bank_mask:0xf
    v_and_b32_dpp v46, v33, v14 quad_perm:[3,3,3,3] row_mask:0xf bank_mask:0xf
    v_and_b32_dpp v47, v33, v15 quad_perm:[3,3,3,3] row_mask:0xf bank_mask:0xf
    v_xor_b32 v65, 0x5000, v61
    s_waitcnt vmcnt(24)
    v_mfma_f32_16x16x32_bf16 v[16:19], v[136:139], v[48:51], v[16:19]
    buffer_load_dwordx4 v[136:139], v65, s[8:11], 0 offen nt
    v_and_b32_dpp v50, v31, v14 quad_perm:[0,0,0,0] row_mask:0xf bank_mask:0xf
    v_and_b32_dpp v51, v31, v15 quad_perm:[0,0,0,0] row_mask:0xf bank_mask:0xf
    v_and_b32_dpp v48, v33, v12 quad_perm:[3,3,3,3] row_mask:0xf bank_mask:0xf
    v_and_b32_dpp v49, v33, v13 quad_perm:[3,3,3,3] row_mask:0xf bank_mask:0xf
    v_xor_b32 v64, 0x10300, v61
    s_waitcnt vmcnt(24)
    v_mfma_f32_16x16x32_bf16 v[16:19], v[140:143], v[44:47], v[16:19]
    buffer_load_dwordx4 v[140:143], v64, s[8:11], 0 offen nt
    v_and_b32_dpp v44, v30, v12 quad_perm:[1,1,1,1] row_mask:0xf bank_mask:0xf
    v_and_b32_dpp v45, v30, v13 quad_perm:[1,1,1,1] row_mask:0xf bank_mask:0xf
    v_and_b32_dpp v46, v32, v14 quad_perm:[2,2,2,2] row_mask:0xf bank_mask:0xf
    v_and_b32_dpp v47, v32, v15 quad_perm:[2,2,2,2] row_mask:0xf bank_mask:0xf
    v_xor_b32 v65, 0x15200, v61
    s_waitcnt vmcnt(24)
    v_mfma_f32_16x16x32_bf16 v[16:19], v[144:147], v[48:51], v[16:19]
    buffer_load_dwordx4 v[144:147], v65, s[8:11], 0 offen nt
    v_and_b32_dpp v50, v30, v14 quad_perm:[1,1,1,1] row_mask:0xf bank_mask:0xf
    v_and_b32_dpp v51, v30, v15 quad_perm:[1,1,1,1] row_mask:0xf bank_mask:0xf
    v_and_b32_dpp v48, v32, v12 quad_perm:[2,2,2,2] row_mask:0xf bank_mask:0xf
    v_and_b32_dpp v49, v32, v13 quad_perm:[2,2,2,2] row_mask:0xf bank_mask:0xf
    v_xor_b32 v64, 0x202300, v61
    s_waitcnt vmcnt(24)
    v_mfma_f32_16x16x32_bf16 v[16:19], v[148:151], v[44:47], v[16:19]
    buffer_load_dwordx4 v[148:151], v64, s[8:11], 0 offen nt
    v_and_b32_dpp v44, v31, v12 quad_perm:[1,1,1,1] row_mask:0xf bank_mask:0xf
    v_and_b32_dpp v45, v31, v13 quad_perm:[1,1,1,1] row_mask:0xf bank_mask:0xf
    v_and_b32_dpp v46, v33, v14 quad_perm:[2,2,2,2] row_mask:0xf bank_mask:0xf
    v_and_b32_dpp v47, v33, v15 quad_perm:[2,2,2,2] row_mask:0xf bank_mask:0xf
    v_xor_b32 v65, 0x207200, v61
    s_waitcnt vmcnt(24)
    v_mfma_f32_16x16x32_bf16 v[16:19], v[152:155], v[48:51], v[16:19]
    buffer_load_dwordx4 v[152:155], v65, s[8:11], 0 offen nt
    v_and_b32_dpp v50, v31, v14 quad_perm:[1,1,1,1] row_mask:0xf bank_mask:0xf
    v_and_b32_dpp v51, v31, v15 quad_perm:[1,1,1,1] row_mask:0xf bank_mask:0xf
    v_and_b32_dpp v48, v33, v12 quad_perm:[2,2,2,2] row_mask:0xf bank_mask:0xf
    v_and_b32_dpp v49, v33, v13 quad_perm:[2,2,2,2] row_mask:0xf bank_mask:0xf
    v_xor_b32 v64, 0x212100, v61
    s_waitcnt vmcnt(24)
    v_mfma_f32_16x16x32_bf16 v[16:19], v[156:159], v[44:47], v[16:19]
    buffer_load_dwordx4 v[156:159], v64, s[8:11], 0 offen nt
    v_and_b32_dpp v44, v30, v12 quad_perm:[2,2,2,2] row_mask:0xf bank_mask:0xf
    v_and_b32_dpp v45, v30, v13 quad_perm:[2,2,2,2] row_mask:0xf bank_mask:0xf
    v_and_b32_dpp v46, v32, v14 quad_perm:[1,1,1,1] row_mask:0xf bank_mask:0xf
    v_and_b32_dpp v47, v32, v15 quad_perm:[1,1,1,1] row_mask:0xf bank_mask:0xf
    v_xor_b32 v65, 0x217000, v61
    s_waitcnt vmcnt(24)
    v_mfma_f32_16x16x32_bf16 v[16:19], v[160:163], v[48:51], v[16:19]
    buffer_load_dwordx4 v[160:163], v65, s[8:11], 0 offen nt
    v_and_b32_dpp v50, v30, v14 quad_perm:[2,2,2,2] row_mask:0xf bank_mask:0xf
    v_and_b32_dpp v51, v30, v15 quad_perm:[2,2,2,2] row_mask:0xf bank_mask:0xf
    v_and_b32_dpp v48, v32, v12 quad_perm:[1,1,1,1] row_mask:0xf bank_mask:0xf
    v_and_b32_dpp v49, v32, v13 quad_perm:[1,1,1,1] row_mask:0xf bank_mask:0xf
    v_xor_b32 v64, 0x20500, v61
    s_waitcnt vmcnt(24)
    v_mfma_f32_16x16x32_bf16 v[16:19], v[164:167], v[44:47], v[16:19]
    buffer_load_dwordx4 v[164:167], v64, s[8:11], 0 offen nt
    v_and_b32_dpp v44, v31, v12 quad_perm:[2,2,2,2] row_mask:0xf bank_mask:0xf
    v_and_b32_dpp v45, v31, v13 quad_perm:[2,2,2,2] row_mask:0xf bank_mask:0xf
    v_and_b32_dpp v46, v33, v14 quad_perm:[1,1,1,1] row_mask:0xf bank_mask:0xf
    v_and_b32_dpp v47, v33, v15 quad_perm:[1,1,1,1] row_mask:0xf bank_mask:0xf
    v_xor_b32 v65, 0x25400, v61
    s_waitcnt vmcnt(24)
    v_mfma_f32_16x16x32_bf16 v[16:19], v[168:171], v[48:51], v[16:19]
    buffer_load_dwordx4 v[168:171], v65, s[8:11], 0 offen nt
    v_and_b32_dpp v50, v31, v14 quad_perm:[2,2,2,2] row_mask:0xf bank_mask:0xf
    v_and_b32_dpp v51, v31, v15 quad_perm:[2,2,2,2] row_mask:0xf bank_mask:0xf
    v_and_b32_dpp v48, v33, v12 quad_perm:[1,1,1,1] row_mask:0xf bank_mask:0xf
    v_and_b32_dpp v49, v33, v13 quad_perm:[1,1,1,1] row_mask:0xf bank_mask:0xf
    v_xor_b32 v64, 0x30700, v61
    s_waitcnt vmcnt(24)
    v_mfma_f32_16x16x32_bf16 v[16:19], v[172:175], v[44:47], v[16:19]
    buffer_load_dwordx4 v[172:175], v64, s[8:11], 0 offen nt
    v_and_b32_dpp v44, v30, v12 quad_perm:[3,3,3,3] row_mask:0xf bank_mask:0xf
    v_and_b32_dpp v45, v30, v13 quad_perm:[3,3,3,3] row_mask:0xf bank_mask:0xf
    v_and_b32_dpp v46, v32, v14 quad_perm:[0,0,0,0] row_mask:0xf bank_mask:0xf
    v_and_b32_dpp v47, v32, v15 quad_perm:[0,0,0,0] row_mask:0xf bank_mask:0xf
    v_xor_b32 v65, 0x35600, v61
    s_waitcnt vmcnt(24)
    v_mfma_f32_16x16x32_bf16 v[16:19], v[176:179], v[48:51], v[16:19]
    buffer_load_dwordx4 v[176:179], v65, s[8:11], 0 offen nt
    v_and_b32_dpp v50, v30, v14 quad_perm:[3,3,3,3] row_mask:0xf bank_mask:0xf
    v_and_b32_dpp v51, v30, v15 quad_perm:[3,3,3,3] row_mask:0xf bank_mask:0xf
    v_and_b32_dpp v48, v32, v12 quad_perm:[0,0,0,0] row_mask:0xf bank_mask:0xf
    v_and_b32_dpp v49, v32, v13 quad_perm:[0,0,0,0] row_mask:0xf bank_mask:0xf
    v_xor_b32 v64, 0x222700, v61
    s_waitcnt vmcnt(24)
    v_mfma_f32_16x16x32_bf16 v[16:19], v[180:183], v[44:47], v[16:19]
    buffer_load_dwordx4 v[180:183], v64, s[8:11], 0 offen nt
    v_and_b32_dpp v44, v31, v12 quad_perm:[3,3,3,3] row_mask:0xf bank_mask:0xf
    v_and_b32_dpp v45, v31, v13 quad_perm:[3,3,3,3] row_mask:0xf bank_mask:0xf
    v_and_b32_dpp v46, v33, v14 quad_perm:[0,0,0,0] row_mask:0xf bank_mask:0xf
    v_and_b32_dpp v47, v33, v15 quad_perm:[0,0,0,0] row_mask:0xf bank_mask:0xf
    v_xor_b32 v65, 0x227600, v61
    s_waitcnt vmcnt(24)
    v_mfma_f32_16x16x32_bf16 v[16:19], v[184:187], v[48:51], v[16:19]
    buffer_load_dwordx4 v[184:187], v65, s[8:11], 0 offen nt
    v_and_b32_dpp v50, v31, v14 quad_perm:[3,3,3,3] row_mask:0xf bank_mask:0xf
    v_and_b32_dpp v51, v31, v15 quad_perm:[3,3,3,3] row_mask:0xf bank_mask:0xf
    v_and_b32_dpp v48, v33, v12 quad_perm:[0,0,0,0] row_mask:0xf bank_mask:0xf
    v_and_b32_dpp v49, v33, v13 quad_perm:[0,0,0,0] row_mask:0xf bank_mask:0xf
    v_xor_b32 v64, 0x232500, v61
    s_waitcnt vmcnt(24)
    v_mfma_f32_16x16x32_bf16 v[16:19], v[188:191], v[44:47], v[16:19]
    buffer_load_dwordx4 v[188:191], v64, s[8:11], 0 offen nt
    s_waitcnt lgkmcnt(0)
    v_sub_f32 v26, v28, v20
    v_sub_f32 v27, v29, v20
    ds_read_b64 v[28:29], v34 offset:1536
    v_exp_f32 v26, v26
    v_exp_f32 v27, v27
    v_cvt_pk_bf16_f32 v30, v26, v26
    v_cvt_pk_bf16_f32 v31, v27, v27
    v_add_f32 v21, v21, v26
    v_mov_b32_dpp v32, v30 row_half_mirror row_mask:0xf bank_mask:0xf
    v_mov_b32_dpp v33, v31 row_half_mirror row_mask:0xf bank_mask:0xf
    v_add_f32 v21, v21, v27
    v_and_b32_dpp v44, v30, v12 quad_perm:[0,0,0,0] row_mask:0xf bank_mask:0xf
    v_and_b32_dpp v45, v30, v13 quad_perm:[0,0,0,0] row_mask:0xf bank_mask:0xf
    v_and_b32_dpp v46, v32, v14 quad_perm:[3,3,3,3] row_mask:0xf bank_mask:0xf
    v_and_b32_dpp v47, v32, v15 quad_perm:[3,3,3,3] row_mask:0xf bank_mask:0xf
    v_xor_b32 v65, 0x237400, v61
    s_waitcnt vmcnt(24)
    v_mfma_f32_16x16x32_bf16 v[16:19], v[192:195], v[48:51], v[16:19]
    buffer_load_dwordx4 v[192:195], v65, s[8:11], 0 offen nt
    v_add_u32 v34, 1024, v34
    s_cmp_lg_u32 s26, 28
    s_cbranch_scc1 L_vloopA
L_vloopB:
    s_add_u32 s26, s26, 1
    v_readlane_b32 s25, v59, s26
    s_nop 1
    v_xor_b32 v61, s25, v1
    v_and_b32_dpp v50, v30, v14 quad_perm:[0,0,0,0] row_mask:0xf bank_mask:0xf
    v_and_b32_dpp v51, v30, v15 quad_perm:[0,0,0,0] row_mask:0xf bank_mask:0xf
    v_and_b32_dpp v48, v32, v12 quad_perm:[3,3,3,3] row_mask:0xf bank_mask:0xf
    v_and_b32_dpp v49, v32, v13 quad_perm:[3,3,3,3] row_mask:0xf bank_mask:0xf
    s_waitcnt vmcnt(31)
    v_mfma_f32_16x16x32_bf16 v[16:19], v[68:71], v[44:47], v[16:19]
    buffer_load_dwordx4 v[68:71], v61, s[8:11], 0 offen nt
    v_and_b32_dpp v44, v31, v12 quad_perm:[0,0,0,0] row_mask:0xf bank_mask:0xf
    v_and_b32_dpp v45, v31, v13 quad_perm:[0,0,0,0] row_mask:0xf bank_mask:0xf
    v_and_b32_dpp v46, v33, v14 quad_perm:[3,3,3,3] row_mask:0xf bank_mask:0xf
    v_and_b32_dpp v47, v33, v15 quad_perm:[3,3,3,3] row_mask:0xf bank_mask:0xf
    v_xor_b32 v65, 0x5100, v61
    s_waitcnt vmcnt(31)
    v_mfma_f32_16x16x32_bf16 v[16:19], v[72:75], v[48:51], v[16:19]
    buffer_load_dwordx4 v[72:75], v65, s[8:11], 0 offen nt
    v_and_b32_dpp v50, v31, v14 quad_perm:[0,0,0,0] row_mask:0xf bank_mask:0xf
    v_and_b32_dpp v51, v31, v15 quad_perm:[0,0,0,0] row_mask:0xf bank_mask:0xf
    v_and_b32_dpp v48, v33, v12 quad_perm:[3,3,3,3] row_mask:0xf bank_mask:0xf
    v_and_b32_dpp v49, v33, v13 quad_perm:[3,3,3,3] row_mask:0xf bank_mask:0xf
    v_xor_b32 v64, 0x10200, v61
    s_waitcnt vmcnt(31)
    v_mfma_f32_16x16x32_bf16 v[16:19], v[76:79], v[44:47], v[16:19]
    buffer_load_dwordx4 v[76:79], v64, s[8:11], 0 offen nt
    v_and_b32_dpp v44, v30, v12 quad_perm:[1,1,1,1] row_mask:0xf bank_mask:0xf
    v_and_b32_dpp v45, v30, v13 quad_perm:[1,1,1,1] row_mask:0xf bank_mask:0xf
    v_and_b32_dpp v46, v32, v14 quad_perm:[2,2,2,2] row_mask:0xf bank_mask:0xf
    v_and_b32_dpp v47, v32, v15 quad_perm:[2,2,2,2] row_mask:0xf bank_mask:0xf
    v_xor_b32 v65, 0x15300, v61
    s_waitcnt vmcnt(31)
    v_mfma_f32_16x16x32_bf16 v[16:19], v[80:83], v[48:51], v[16:19]
    buffer_load_dwordx4 v[80:83], v65, s[8:11], 0 offen nt
    v_and_b32_dpp v50, v30, v14 quad_perm:[1,1,1,1] row_mask:0xf bank_mask:0xf
    v_and_b32_dpp v51, v30, v15 quad_perm:[1,1,1,1] row_mask:0xf bank_mask:0xf
    v_and_b32_dpp v48, v32, v12 quad_perm:[2,2,2,2] row_mask:0xf bank_mask:0xf
    v_and_b32_dpp v49, v32, v13 quad_perm:[2,2,2,2] row_mask:0xf bank_mask:0xf
    v_xor_b32 v64, 0x202200, v61
    s_waitcnt vmcnt(31)
    v_mfma_f32_16x16x32_bf16 v[16:19], v[84:87], v[44:47], v[16:19]
    buffer_load_dwordx4 v[84:87], v64, s[8:11], 0 offen nt
    v_and_b32_dpp v44, v31, v12 quad_perm:[1,1,1,1] row_mask:0xf bank_mask:0xf
    v_and_b32_dpp v45, v31, v13 quad_perm:[1,1,1,1] row_mask:0xf bank_mask:0xf
    v_and_b32_dpp v46, v33, v14 quad_perm:[2,2,2,2] row_mask:0xf bank_mask:0xf
    v_and_b32_dpp v47, v33, v15 quad_perm:[2,2,2,2] row_mask:0xf bank_mask:0xf
    v_xor_b32 v65, 0x207300, v61
    s_waitcnt vmcnt(31)
    v_mfma_f32_16x16x32_bf16 v[16:19], v[88:91], v[48:51], v[16:19]
    buffer_load_dwordx4 v[88:91], v65, s[8:11], 0 offen nt
    v_and_b32_dpp v50, v31, v14 quad_perm:[1,1,1,1] row_mask:0xf bank_mask:0xf
    v_and_b32_dpp v51, v31, v15 quad_perm:[1,1,1,1] row_mask:0xf bank_mask:0xf
    v_and_b32_dpp v48, v33, v12 quad_perm:[2,2,2,2] row_mask:0xf bank_mask:0xf
    v_and_b32_dpp v49, v33, v13 quad_perm:[2,2,2,2] row_mask:0xf bank_mask:0xf
    v_xor_b32 v64, 0x212000, v61
    s_waitcnt vmcnt(31)
    v_mfma_f32_16x16x32_bf16 v[16:19], v[92:95], v[44:47], v[16:19]
    buffer_load_dwordx4 v[92:95], v64, s[8:11], 0 offen nt
    v_and_b32_dpp v44, v30, v12 quad_perm:[2,2,2,2] row_mask:0xf bank_mask:0xf
    v_and_b32_dpp v45, v30, v13 quad_perm:[2,2,2,2] row_mask:0xf bank_mask:0xf
    v_and_b32_dpp v46, v32, v14 quad_perm:[1,1,1,1] row_mask:0xf bank_mask:0xf
    v_and_b32_dpp v47, v32, v15 quad_perm:[1,1,1,1] row_mask:0xf bank_mask:0xf
    v_xor_b32 v65, 0x217100, v61
    s_waitcnt vmcnt(31)
    v_mfma_f32_16x16x32_bf16 v[16:19], v[96:99], v[48:51], v[16:19]
    buffer_load_dwordx4 v[96:99], v65, s[8:11], 0 offen nt
    v_and_b32_dpp v50, v30, v14 quad_perm:[2,2,2,2] row_mask:0xf bank_mask:0xf
    v_and_b32_dpp v51, v30, v15 quad_perm:[2,2,2,2] row_mask:0xf bank_mask:0xf
    v_and_b32_dpp v48, v32, v12 quad_perm:[1,1,1,1] row_mask:0xf bank_mask:0xf
    v_and_b32_dpp v49, v32, v13 quad_perm:[1,1,1,1] row_mask:0xf bank_mask:0xf
    v_xor_b32 v64, 0x20400, v61
    s_waitcnt vmcnt(31)
    v_mfma_f32_16x16x32_bf16 v[16:19], v[100:103], v[44:47], v[16:19]
    buffer_load_dwordx4 v[100:103], v64, s[8:11], 0 offen nt
    v_and_b32_dpp v44, v31, v12 quad_perm:[2,2,2,2] row_mask:0xf bank_mask:0xf
    v_and_b32_dpp v45, v31, v13 quad_perm:[2,2,2,2] row_mask:0xf bank_mask:0xf
    v_and_b32_dpp v46, v33, v14 quad_perm:[1,1,1,1] row_mask:0xf bank_mask:0xf
    v_and_b32_dpp v47, v33, v15 quad_perm:[1,1,1,1] row_mask:0xf bank_mask:0xf
    v_xor_b32 v65, 0x25500, v61
    s_waitcnt vmcnt(31)
    v_mfma_f32_16x16x32_bf16 v[16:19], v[104:107], v[48:51], v[16:19]
    buffer_load_dwordx4 v[104:107], v65, s[8:11], 0 offen nt
    v_and_b32_dpp v50, v31, v14 quad_perm:[2,2,2,2] row_mask:0xf bank_mask:0xf
    v_and_b32_dpp v51, v31, v15 quad_perm:[2,2,2,2] row_mask:0xf bank_mask:0xf
    v_and_b32_dpp v48, v33, v12 quad_perm:[1,1,1,1] row_mask:0xf bank_mask:0xf
    v_and_b32_dpp v49, v33, v13 quad_perm:[1,1,1,1] row_mask:0xf bank_mask:0xf
    v_xor_b32 v64, 0x30600, v61
    s_waitcnt vmcnt(31)
    v_mfma_f32_16x16x32_bf16 v[16:19], v[108:111], v[44:47], v[16:19]
    buffer_load_dwordx4 v[108:111], v64, s[8:11], 0 offen nt
    v_and_b32_dpp v44, v30, v12 quad_perm:[3,3,3,3] row_mask:0xf bank_mask:0xf
    v_and_b32_dpp v45, v30, v13 quad_perm:[3,3,3,3] row_mask:0xf bank_mask:0xf
    v_and_b32_dpp v46, v32, v14 quad_perm:[0,0,0,0] row_mask:0xf bank_mask:0xf
    v_and_b32_dpp v47, v32, v15 quad_perm:[0,0,0,0] row_mask:0xf bank_mask:0xf
    v_xor_b32 v65, 0x35700, v61
    s_waitcnt vmcnt(31)
    v_mfma_f32_16x16x32_bf16 v[16:19], v[112:115], v[48:51], v[16:19]
    buffer_load_dwordx4 v[112:115], v65, s[8:11], 0 offen nt
    v_and_b32_dpp v50, v30, v14 quad_perm:[3,3,3,3] row_mask:0xf bank_mask:0xf
    v_and_b32_dpp v51, v30, v15 quad_perm:[3,3,3,3] row_mask:0xf bank_mask:0xf
    v_and_b32_dpp v48, v32, v12 quad_perm:[0,0,0,0] row_mask:0xf bank_mask:0xf
    v_and_b32_dpp v49, v32, v13 quad_perm:[0,0,0,0] row_mask:0xf bank_mask:0xf
    v_xor_b32 v64, 0x222600, v61
    s_waitcnt vmcnt(31)
    v_mfma_f32_16x16x32_bf16 v[16:19], v[116:119], v[44:47], v[16:19]
    buffer_load_dwordx4 v[116:119], v64, s[8:11], 0 offen nt
    v_and_b32_dpp v44, v31, v12 quad_perm:[3,3,3,3] row_mask:0xf bank_mask:0xf
    v_and_b32_dpp v45, v31, v13 quad_perm:[3,3,3,3] row_mask:0xf bank_mask:0xf
    v_and_b32_dpp v46, v33, v14 quad_perm:[0,0,0,0] row_mask:0xf bank_mask:0xf
    v_and_b32_dpp v47, v33, v15 quad_perm:[0,0,0,0] row_mask:0xf bank_mask:0xf
    v_xor_b32 v65, 0x227700, v61
    s_waitcnt vmcnt(31)
    v_mfma_f32_16x16x32_bf16 v[16:19], v[120:123], v[48:51], v[16:19]
    buffer_load_dwordx4 v[120:123], v65, s[8:11], 0 offen nt
    v_and_b32_dpp v50, v31, v14 quad_perm:[3,3,3,3] row_mask:0xf bank_mask:0xf
    v_and_b32_dpp v51, v31, v15 quad_perm:[3,3,3,3] row_mask:0xf bank_mask:0xf
    v_and_b32_dpp v48, v33, v12 quad_perm:[0,0,0,0] row_mask:0xf bank_mask:0xf
    v_and_b32_dpp v49, v33, v13 quad_perm:[0,0,0,0] row_mask:0xf bank_mask:0xf
    v_xor_b32 v64, 0x232400, v61
    s_waitcnt vmcnt(31)
    v_mfma_f32_16x16x32_bf16 v[16:19], v[124:127], v[44:47], v[16:19]
    buffer_load_dwordx4 v[124:127], v64, s[8:11], 0 offen nt
    s_waitcnt lgkmcnt(0)
    v_sub_f32 v26, v28, v20
    v_sub_f32 v27, v29, v20
    ds_read_b64 v[28:29], v34 offset:1024
    v_exp_f32 v26, v26
    v_exp_f32 v27, v27
    v_cvt_pk_bf16_f32 v30, v26, v26
    v_cvt_pk_bf16_f32 v31, v27, v27
    v_add_f32 v21, v21, v26
    v_mov_b32_dpp v32, v30 row_half_mirror row_mask:0xf bank_mask:0xf
    v_mov_b32_dpp v33, v31 row_half_mirror row_mask:0xf bank_mask:0xf
    v_add_f32 v21, v21, v27
    v_and_b32_dpp v44, v30, v12 quad_perm:[0,0,0,0] row_mask:0xf bank_mask:0xf
    v_and_b32_dpp v45, v30, v13 quad_perm:[0,0,0,0] row_mask:0xf bank_mask:0xf
    v_and_b32_dpp v46, v32, v14 quad_perm:[3,3,3,3] row_mask:0xf bank_mask:0xf
    v_and_b32_dpp v47, v32, v15 quad_perm:[3,3,3,3] row_mask:0xf bank_mask:0xf
    v_xor_b32 v65, 0x237500, v61
    s_waitcnt vmcnt(31)
    v_mfma_f32_16x16x32_bf16 v[16:19], v[128:131], v[48:51], v[16:19]
    buffer_load_dwordx4 v[128:131], v65, s[8:11], 0 offen nt
    v_and_b32_dpp v50, v30, v14 quad_perm:[0,0,0,0] row_mask:0xf bank_mask:0xf
    v_and_b32_dpp v51, v30, v15 quad_perm:[0,0,0,0] row_mask:0xf bank_mask:0xf
    v_and_b32_dpp v48, v32, v12 quad_perm:[3,3,3,3] row_mask:0xf bank_mask:0xf
    v_and_b32_dpp v49, v32, v13 quad_perm:[3,3,3,3] row_mask:0xf bank_mask:0xf
    v_xor_b32 v64, 0x100, v61
    s_waitcnt vmcnt(31)
    v_mfma_f32_16x16x32_bf16 v[16:19], v[132:135], v[44:47], v[16:19]
    buffer_load_dwordx4 v[132:135], v64, s[8:11], 0 offen nt
    v_and_b32_dpp v44, v31, v12 quad_perm:[0,0,0,0] row_mask:0xf bank_mask:0xf
    v_and_b32_dpp v45, v31, v13 quad_perm:[0,0,0,0] row_mask:0xf bank_mask:0xf
    v_and_b32_dpp v46, v33, v14 quad_perm:[3,3,3,3] row_mask:0xf bank_mask:0xf
    v_and_b32_dpp v47, v33, v15 quad_perm:[3,3,3,3] row_mask:0xf bank_mask:0xf
    v_xor_b32 v65, 0x5000, v61
    s_waitcnt vmcnt(31)
    v_mfma_f32_16x16x32_bf16 v[16:19], v[136:139], v[48:51], v[16:19]
    buffer_load_dwordx4 v[136:139], v65, s[8:11], 0 offen nt
    v_and_b32_dpp v50, v31, v14 quad_perm:[0,0,0,0] row_mask:0xf bank_mask:0xf
    v_and_b32_dpp v51, v31, v15 quad_perm:[0,0,0,0] row_mask:0xf bank_mask:0xf
    v_and_b32_dpp v48, v33, v12 quad_perm:[3,3,3,3] row_mask:0xf bank_mask:0xf
    v_and_b32_dpp v49, v33, v13 quad_perm:[3,3,3,3] row_mask:0xf bank_mask:0xf
    v_xor_b32 v64, 0x10300, v61
    s_waitcnt vmcnt(31)
    v_mfma_f32_16x16x32_bf16 v[16:19], v[140:143], v[44:47], v[16:19]
    buffer_load_dwordx4 v[140:143], v64, s[8:11], 0 offen nt
    v_and_b32_dpp v44, v30, v12 quad_perm:[1,1,1,1] row_mask:0xf bank_mask:0xf
    v_and_b32_dpp v45, v30, v13 quad_perm:[1,1,1,1] row_mask:0xf bank_mask:0xf
    v_and_b32_dpp v46, v32, v14 quad_perm:[2,2,2,2] row_mask:0xf bank_mask:0xf
    v_and_b32_dpp v47, v32, v15 quad_perm:[2,2,2,2] row_mask:0xf bank_mask:0xf
    v_xor_b32 v65, 0x15200, v61
    s_waitcnt vmcnt(31)
    v_mfma_f32_16x16x32_bf16 v[16:19], v[144:147], v[48:51], v[16:19]
    buffer_load_dwordx4 v[144:147], v65, s[8:11], 0 offen nt
    v_and_b32_dpp v50, v30, v14 quad_perm:[1,1,1,1] row_mask:0xf bank_mask:0xf
    v_and_b32_dpp v51, v30, v15 quad_perm:[1,1,1,1] row_mask:0xf bank_mask:0xf
    v_and_b32_dpp v48, v32, v12 quad_perm:[2,2,2,2] row_mask:0xf bank_mask:0xf
    v_and_b32_dpp v49, v32, v13 quad_perm:[2,2,2,2] row_mask:0xf bank_mask:0xf
    v_xor_b32 v64, 0x202300, v61
    s_waitcnt vmcnt(31)
    v_mfma_f32_16x16x32_bf16 v[16:19], v[148:151], v[44:47], v[16:19]
    buffer_load_dwordx4 v[148:151], v64, s[8:11], 0 offen nt
    v_and_b32_dpp v44, v31, v12 quad_perm:[1,1,1,1] row_mask:0xf bank_mask:0xf
    v_and_b32_dpp v45, v31, v13 quad_perm:[1,1,1,1] row_mask:0xf bank_mask:0xf
    v_and_b32_dpp v46, v33, v14 quad_perm:[2,2,2,2] row_mask:0xf bank_mask:0xf
    v_and_b32_dpp v47, v33, v15 quad_perm:[2,2,2,2] row_mask:0xf bank_mask:0xf
    v_xor_b32 v65, 0x207200, v61
    s_waitcnt vmcnt(31)
    v_mfma_f32_16x16x32_bf16 v[16:19], v[152:155], v[48:51], v[16:19]
    buffer_load_dwordx4 v[152:155], v65, s[8:11], 0 offen nt
    v_and_b32_dpp v50, v31, v14 quad_perm:[1,1,1,1] row_mask:0xf bank_mask:0xf
    v_and_b32_dpp v51, v31, v15 quad_perm:[1,1,1,1] row_mask:0xf bank_mask:0xf
    v_and_b32_dpp v48, v33, v12 quad_perm:[2,2,2,2] row_mask:0xf bank_mask:0xf
    v_and_b32_dpp v49, v33, v13 quad_perm:[2,2,2,2] row_mask:0xf bank_mask:0xf
    v_xor_b32 v64, 0x212100, v61
    s_waitcnt vmcnt(31)
    v_mfma_f32_16x16x32_bf16 v[16:19], v[156:159], v[44:47], v[16:19]
    buffer_load_dwordx4 v[156:159], v64, s[8:11], 0 offen nt
    v_and_b32_dpp v44, v30, v12 quad_perm:[2,2,2,2] row_mask:0xf bank_mask:0xf
    v_and_b32_dpp v45, v30, v13 quad_perm:[2,2,2,2] row_mask:0xf bank_mask:0xf
    v_and_b32_dpp v46, v32, v14 quad_perm:[1,1,1,1] row_mask:0xf bank_mask:0xf
    v_and_b32_dpp v47, v32, v15 quad_perm:[1,1,1,1] row_mask:0xf bank_mask:0xf
    v_xor_b32 v65, 0x217000, v61
    s_waitcnt vmcnt(31)
    v_mfma_f32_16x16x32_bf16 v[16:19], v[160:163], v[48:51], v[16:19]
    buffer_load_dwordx4 v[160:163], v65, s[8:11], 0 offen nt
    v_and_b32_dpp v50, v30, v14 quad_perm:[2,2,2,2] row_mask:0xf bank_mask:0xf
    v_and_b32_dpp v51, v30, v15 quad_perm:[2,2,2,2] row_mask:0xf bank_mask:0xf
    v_and_b32_dpp v48, v32, v12 quad_perm:[1,1,1,1] row_mask:0xf bank_mask:0xf
    v_and_b32_dpp v49, v32, v13 quad_perm:[1,1,1,1] row_mask:0xf bank_mask:0xf
    v_xor_b32 v64, 0x20500, v61
    s_waitcnt vmcnt(31)
    v_mfma_f32_16x16x32_bf16 v[16:19], v[164:167], v[44:47], v[16:19]
    buffer_load_dwordx4 v[164:167], v64, s[8:11], 0 offen nt
    v_and_b32_dpp v44, v31, v12 quad_perm:[2,2,2,2] row_mask:0xf bank_mask:0xf
    v_and_b32_dpp v45, v31, v13 quad_perm:[2,2,2,2] row_mask:0xf bank_mask:0xf
    v_and_b32_dpp v46, v33, v14 quad_perm:[1,1,1,1] row_mask:0xf bank_mask:0xf
    v_and_b32_dpp v47, v33, v15 quad_perm:[1,1,1,1] row_mask:0xf bank_mask:0xf
    v_xor_b32 v65, 0x25400, v61
    s_waitcnt vmcnt(31)
    v_mfma_f32_16x16x32_bf16 v[16:19], v[168:171], v[48:51], v[16:19]
    buffer_load_dwordx4 v[168:171], v65, s[8:11], 0 offen nt
    v_and_b32_dpp v50, v31, v14 quad_perm:[2,2,2,2] row_mask:0xf bank_mask:0xf
    v_and_b32_dpp v51, v31, v15 quad_perm:[2,2,2,2] row_mask:0xf bank_mask:0xf
    v_and_b32_dpp v48, v33, v12 quad_perm:[1,1,1,1] row_mask:0xf bank_mask:0xf
    v_and_b32_dpp v49, v33, v13 quad_perm:[1,1,1,1] row_mask:0xf bank_mask:0xf
    v_xor_b32 v64, 0x30700, v61
    s_waitcnt vmcnt(31)
    v_mfma_f32_16x16x32_bf16 v[16:19], v[172:175], v[44:47], v[16:19]
    buffer_load_dwordx4 v[172:175], v64, s[8:11], 0 offen nt
    v_and_b32_dpp v44, v30, v12 quad_perm:[3,3,3,3] row_mask:0xf bank_mask:0xf
    v_and_b32_dpp v45, v30, v13 quad_perm:[3,3,3,3] row_mask:0xf bank_mask:0xf
    v_and_b32_dpp v46, v32, v14 quad_perm:[0,0,0,0] row_mask:0xf bank_mask:0xf
    v_and_b32_dpp v47, v32, v15 quad_perm:[0,0,0,0] row_mask:0xf bank_mask:0xf
    v_xor_b32 v65, 0x35600, v61
    s_waitcnt vmcnt(31)
    v_mfma_f32_16x16x32_bf16 v[16:19], v[176:179], v[48:51], v[16:19]
    buffer_load_dwordx4 v[176:179], v65, s[8:11], 0 offen nt
    v_and_b32_dpp v50, v30, v14 quad_perm:[3,3,3,3] row_mask:0xf bank_mask:0xf
    v_and_b32_dpp v51, v30, v15 quad_perm:[3,3,3,3] row_mask:0xf bank_mask:0xf
    v_and_b32_dpp v48, v32, v12 quad_perm:[0,0,0,0] row_mask:0xf bank_mask:0xf
    v_and_b32_dpp v49, v32, v13 quad_perm:[0,0,0,0] row_mask:0xf bank_mask:0xf
    v_xor_b32 v64, 0x222700, v61
    s_waitcnt vmcnt(31)
    v_mfma_f32_16x16x32_bf16 v[16:19], v[180:183], v[44:47], v[16:19]
    buffer_load_dwordx4 v[180:183], v64, s[8:11], 0 offen nt
    v_and_b32_dpp v44, v31, v12 quad_perm:[3,3,3,3] row_mask:0xf bank_mask:0xf
    v_and_b32_dpp v45, v31, v13 quad_perm:[3,3,3,3] row_mask:0xf bank_mask:0xf
    v_and_b32_dpp v46, v33, v14 quad_perm:[0,0,0,0] row_mask:0xf bank_mask:0xf
    v_and_b32_dpp v47, v33, v15 quad_perm:[0,0,0,0] row_mask:0xf bank_mask:0xf
    v_xor_b32 v65, 0x227600, v61
    s_waitcnt vmcnt(31)
    v_mfma_f32_16x16x32_bf16 v[16:19], v[184:187], v[48:51], v[16:19]
    buffer_load_dwordx4 v[184:187], v65, s[8:11], 0 offen nt
    v_and_b32_dpp v50, v31, v14 quad_perm:[3,3,3,3] row_mask:0xf bank_mask:0xf
    v_and_b32_dpp v51, v31, v15 quad_perm:[3,3,3,3] row_mask:0xf bank_mask:0xf
    v_and_b32_dpp v48, v33, v12 quad_perm:[0,0,0,0] row_mask:0xf bank_mask:0xf
    v_and_b32_dpp v49, v33, v13 quad_perm:[0,0,0,0] row_mask:0xf bank_mask:0xf
    v_xor_b32 v64, 0x232500, v61
    s_waitcnt vmcnt(31)
    v_mfma_f32_16x16x32_bf16 v[16:19], v[188:191], v[44:47], v[16:19]
    buffer_load_dwordx4 v[188:191], v64, s[8:11], 0 offen nt
    s_waitcnt lgkmcnt(0)
    v_sub_f32 v26, v28, v20
    v_sub_f32 v27, v29, v20
    ds_read_b64 v[28:29], v34 offset:1536
    v_exp_f32 v26, v26
    v_exp_f32 v27, v27
    v_cvt_pk_bf16_f32 v30, v26, v26
    v_cvt_pk_bf16_f32 v31, v27, v27
    v_add_f32 v21, v21, v26
    v_mov_b32_dpp v32, v30 row_half_mirror row_mask:0xf bank_mask:0xf
    v_mov_b32_dpp v33, v31 row_half_mirror row_mask:0xf bank_mask:0xf
    v_add_f32 v21, v21, v27
    v_and_b32_dpp v44, v30, v12 quad_perm:[0,0,0,0] row_mask:0xf bank_mask:0xf
    v_and_b32_dpp v45, v30, v13 quad_perm:[0,0,0,0] row_mask:0xf bank_mask:0xf
    v_and_b32_dpp v46, v32, v14 quad_perm:[3,3,3,3] row_mask:0xf bank_mask:0xf
    v_and_b32_dpp v47, v32, v15 quad_perm:[3,3,3,3] row_mask:0xf bank_mask:0xf
    v_xor_b32 v65, 0x237400, v61
    s_waitcnt vmcnt(31)
    v_mfma_f32_16x16x32_bf16 v[16:19], v[192:195], v[48:51], v[16:19]
    buffer_load_dwordx4 v[192:195], v65, s[8:11], 0 offen nt
    v_add_u32 v34, 1024, v34
    s_cmp_lg_u32 s26, 31
    s_cbranch_scc1 L_vloopB
    v_cmp_eq_u32 vcc, 0, v56
    s_cbranch_vccnz L_wait
L_ready:
    s_waitcnt lgkmcnt(0)
    v_sub_f32 v26, v28, v20
    v_sub_f32 v27, v29, v20
    v_exp_f32 v26, v26
    v_exp_f32 v27, v27
    v_add_f32 v21, v21, v26
    v_add_f32 v21, v21, v27
    s_nop 1
    v_add_f32_dpp v21, v21, v21 quad_perm:[1,0,3,2] row_mask:0xf bank_mask:0xf
    s_nop 1
    v_add_f32_dpp v21, v21, v21 quad_perm:[2,3,0,1] row_mask:0xf bank_mask:0xf
    s_nop 1
    v_add_f32_dpp v21, v21, v21 row_half_mirror row_mask:0xf bank_mask:0xf
    v_mov_b32 v22, v21
    s_nop 1
    v_permlane16_swap_b32 v21, v22
    v_add_f32 v21, v21, v22
    v_mov_b32 v22, v21
    s_nop 1
    v_permlane32_swap_b32 v21, v22
    v_add_f32 v21, v21, v22
    v_and_b32_dpp v50, v30, v14 quad_perm:[0,0,0,0] row_mask:0xf bank_mask:0xf
    v_and_b32_dpp v51, v30, v15 quad_perm:[0,0,0,0] row_mask:0xf bank_mask:0xf
    v_and_b32_dpp v48, v32, v12 quad_perm:[3,3,3,3] row_mask:0xf bank_mask:0xf
    v_and_b32_dpp v49, v32, v13 quad_perm:[3,3,3,3] row_mask:0xf bank_mask:0xf
    s_waitcnt vmcnt(31)
    v_mfma_f32_16x16x32_bf16 v[16:19], v[68:71], v[44:47], v[16:19]
    v_and_b32_dpp v44, v31, v12 quad_perm:[0,0,0,0] row_mask:0xf bank_mask:0xf
    v_and_b32_dpp v45, v31, v13 quad_perm:[0,0,0,0] row_mask:0xf bank_mask:0xf
    v_and_b32_dpp v46, v33, v14 quad_perm:[3,3,3,3] row_mask:0xf bank_mask:0xf
    v_and_b32_dpp v47, v33, v15 quad_perm:[3,3,3,3] row_mask:0xf bank_mask:0xf
    s_waitcnt vmcnt(30)
    v_mfma_f32_16x16x32_bf16 v[16:19], v[72:75], v[48:51], v[16:19]
    v_and_b32_dpp v50, v31, v14 quad_perm:[0,0,0,0] row_mask:0xf bank_mask:0xf
    v_and_b32_dpp v51, v31, v15 quad_perm:[0,0,0,0] row_mask:0xf bank_mask:0xf
    v_and_b32_dpp v48, v33, v12 quad_perm:[3,3,3,3] row_mask:0xf bank_mask:0xf
    v_and_b32_dpp v49, v33, v13 quad_perm:[3,3,3,3] row_mask:0xf bank_mask:0xf
    s_waitcnt vmcnt(29)
    v_mfma_f32_16x16x32_bf16 v[16:19], v[76:79], v[44:47], v[16:19]
    v_and_b32_dpp v44, v30, v12 quad_perm:[1,1,1,1] row_mask:0xf bank_mask:0xf
    v_and_b32_dpp v45, v30, v13 quad_perm:[1,1,1,1] row_mask:0xf bank_mask:0xf
    v_and_b32_dpp v46, v32, v14 quad_perm:[2,2,2,2] row_mask:0xf bank_mask:0xf
    v_and_b32_dpp v47, v32, v15 quad_perm:[2,2,2,2] row_mask:0xf bank_mask:0xf
    s_waitcnt vmcnt(28)
    v_mfma_f32_16x16x32_bf16 v[16:19], v[80:83], v[48:51], v[16:19]
    v_and_b32_dpp v50, v30, v14 quad_perm:[1,1,1,1] row_mask:0xf bank_mask:0xf
    v_and_b32_dpp v51, v30, v15 quad_perm:[1,1,1,1] row_mask:0xf bank_mask:0xf
    v_and_b32_dpp v48, v32, v12 quad_perm:[2,2,2,2] row_mask:0xf bank_mask:0xf
    v_and_b32_dpp v49, v32, v13 quad_perm:[2,2,2,2] row_mask:0xf bank_mask:0xf
    s_waitcnt vmcnt(27)
    v_mfma_f32_16x16x32_bf16 v[16:19], v[84:87], v[44:47], v[16:19]
    v_and_b32_dpp v44, v31, v12 quad_perm:[1,1,1,1] row_mask:0xf bank_mask:0xf
    v_and_b32_dpp v45, v31, v13 quad_perm:[1,1,1,1] row_mask:0xf bank_mask:0xf
    v_and_b32_dpp v46, v33, v14 quad_perm:[2,2,2,2] row_mask:0xf bank_mask:0xf
    v_and_b32_dpp v47, v33, v15 quad_perm:[2,2,2,2] row_mask:0xf bank_mask:0xf
    s_waitcnt vmcnt(26)
    v_mfma_f32_16x16x32_bf16 v[16:19], v[88:91], v[48:51], v[16:19]
    s_mov_b64 exec, 0x101
    buffer_store_dwordx2 v[20:21], v57, s[20:23], 0 offen sc1
    s_mov_b64 exec, -1
    v_and_b32_dpp v50, v31, v14 quad_perm:[1,1,1,1] row_mask:0xf bank_mask:0xf
    v_and_b32_dpp v51, v31, v15 quad_perm:[1,1,1,1] row_mask:0xf bank_mask:0xf
    v_and_b32_dpp v48, v33, v12 quad_perm:[2,2,2,2] row_mask:0xf bank_mask:0xf
    v_and_b32_dpp v49, v33, v13 quad_perm:[2,2,2,2] row_mask:0xf bank_mask:0xf
    s_waitcnt vmcnt(26)
    v_mfma_f32_16x16x32_bf16 v[16:19], v[92:95], v[44:47], v[16:19]
    v_and_b32_dpp v44, v30, v12 quad_perm:[2,2,2,2] row_mask:0xf bank_mask:0xf
    v_and_b32_dpp v45, v30, v13 quad_perm:[2,2,2,2] row_mask:0xf bank_mask:0xf
    v_and_b32_dpp v46, v32, v14 quad_perm:[1,1,1,1] row_mask:0xf bank_mask:0xf
    v_and_b32_dpp v47, v32, v15 quad_perm:[1,1,1,1] row_mask:0xf bank_mask:0xf
    s_waitcnt vmcnt(25)
    v_mfma_f32_16x16x32_bf16 v[16:19], v[96:99], v[48:51], v[16:19]
    v_and_b32_dpp v50, v30, v14 quad_perm:[2,2,2,2] row_mask:0xf bank_mask:0xf
    v_and_b32_dpp v51, v30, v15 quad_perm:[2,2,2,2] row_mask:0xf bank_mask:0xf
    v_and_b32_dpp v48, v32, v12 quad_perm:[1,1,1,1] row_mask:0xf bank_mask:0xf
    v_and_b32_dpp v49, v32, v13 quad_perm:[1,1,1,1] row_mask:0xf bank_mask:0xf
    s_waitcnt vmcnt(24)
    v_mfma_f32_16x16x32_bf16 v[16:19], v[100:103], v[44:47], v[16:19]
    v_and_b32_dpp v44, v31, v12 quad_perm:[2,2,2,2] row_mask:0xf bank_mask:0xf
    v_and_b32_dpp v45, v31, v13 quad_perm:[2,2,2,2] row_mask:0xf bank_mask:0xf
    v_and_b32_dpp v46, v33, v14 quad_perm:[1,1,1,1] row_mask:0xf bank_mask:0xf
    v_and_b32_dpp v47, v33, v15 quad_perm:[1,1,1,1] row_mask:0xf bank_mask:0xf
    s_waitcnt vmcnt(23)
    v_mfma_f32_16x16x32_bf16 v[16:19], v[104:107], v[48:51], v[16:19]
    v_and_b32_dpp v50, v31, v14 quad_perm:[2,2,2,2] row_mask:0xf bank_mask:0xf
    v_and_b32_dpp v51, v31, v15 quad_perm:[2,2,2,2] row_mask:0xf bank_mask:0xf
    v_and_b32_dpp v48, v33, v12 quad_perm:[1,1,1,1] row_mask:0xf bank_mask:0xf
    v_and_b32_dpp v49, v33, v13 quad_perm:[1,1,1,1] row_mask:0xf bank_mask:0xf
    s_waitcnt vmcnt(22)
    v_mfma_f32_16x16x32_bf16 v[16:19], v[108:111], v[44:47], v[16:19]
    v_and_b32_dpp v44, v30, v12 quad_perm:[3,3,3,3] row_mask:0xf bank_mask:0xf
    v_and_b32_dpp v45, v30, v13 quad_perm:[3,3,3,3] row_mask:0xf bank_mask:0xf
    v_and_b32_dpp v46, v32, v14 quad_perm:[0,0,0,0] row_mask:0xf bank_mask:0xf
    v_and_b32_dpp v47, v32, v15 quad_perm:[0,0,0,0] row_mask:0xf bank_mask:0xf
    s_waitcnt vmcnt(21)
    v_mfma_f32_16x16x32_bf16 v[16:19], v[112:115], v[48:51], v[16:19]
    v_and_b32_dpp v50, v30, v14 quad_perm:[3,3,3,3] row_mask:0xf bank_mask:0xf
    v_and_b32_dpp v51, v30, v15 quad_perm:[3,3,3,3] row_mask:0xf bank_mask:0xf
    v_and_b32_dpp v48, v32, v12 quad_perm:[0,0,0,0] row_mask:0xf bank_mask:0xf
    v_and_b32_dpp v49, v32, v13 quad_perm:[0,0,0,0] row_mask:0xf bank_mask:0xf
    s_waitcnt vmcnt(20)
    v_mfma_f32_16x16x32_bf16 v[16:19], v[116:119], v[44:47], v[16:19]
    v_and_b32_dpp v44, v31, v12 quad_perm:[3,3,3,3] row_mask:0xf bank_mask:0xf
    v_and_b32_dpp v45, v31, v13 quad_perm:[3,3,3,3] row_mask:0xf bank_mask:0xf
    v_and_b32_dpp v46, v33, v14 quad_perm:[0,0,0,0] row_mask:0xf bank_mask:0xf
    v_and_b32_dpp v47, v33, v15 quad_perm:[0,0,0,0] row_mask:0xf bank_mask:0xf
    s_waitcnt vmcnt(19)
    v_mfma_f32_16x16x32_bf16 v[16:19], v[120:123], v[48:51], v[16:19]
    v_and_b32_dpp v50, v31, v14 quad_perm:[3,3,3,3] row_mask:0xf bank_mask:0xf
    v_and_b32_dpp v51, v31, v15 quad_perm:[3,3,3,3] row_mask:0xf bank_mask:0xf
    v_and_b32_dpp v48, v33, v12 quad_perm:[0,0,0,0] row_mask:0xf bank_mask:0xf
    v_and_b32_dpp v49, v33, v13 quad_perm:[0,0,0,0] row_mask:0xf bank_mask:0xf
    s_waitcnt vmcnt(18)
    v_mfma_f32_16x16x32_bf16 v[16:19], v[124:127], v[44:47], v[16:19]
    v_cvt_pk_bf16_f32 v30, v26, v26
    v_cvt_pk_bf16_f32 v31, v27, v27
    s_nop 0
    v_mov_b32_dpp v32, v30 row_half_mirror row_mask:0xf bank_mask:0xf
    v_mov_b32_dpp v33, v31 row_half_mirror row_mask:0xf bank_mask:0xf
    v_and_b32_dpp v44, v30, v12 quad_perm:[0,0,0,0] row_mask:0xf bank_mask:0xf
    v_and_b32_dpp v45, v30, v13 quad_perm:[0,0,0,0] row_mask:0xf bank_mask:0xf
    v_and_b32_dpp v46, v32, v14 quad_perm:[3,3,3,3] row_mask:0xf bank_mask:0xf
    v_and_b32_dpp v47, v32, v15 quad_perm:[3,3,3,3] row_mask:0xf bank_mask:0xf
    s_waitcnt vmcnt(17)
    v_mfma_f32_16x16x32_bf16 v[16:19], v[128:131], v[48:51], v[16:19]
    v_and_b32_dpp v50, v30, v14 quad_perm:[0,0,0,0] row_mask:0xf bank_mask:0xf
    v_and_b32_dpp v51, v30, v15 quad_perm:[0,0,0,0] row_mask:0xf bank_mask:0xf
    v_and_b32_dpp v48, v32, v12 quad_perm:[3,3,3,3] row_mask:0xf bank_mask:0xf
    v_and_b32_dpp v49, v32, v13 quad_perm:[3,3,3,3] row_mask:0xf bank_mask:0xf
    s_waitcnt vmcnt(16)
    v_mfma_f32_16x16x32_bf16 v[16:19], v[132:135], v[44:47], v[16:19]
    v_and_b32_dpp v44, v31, v12 quad_perm:[0,0,0,0] row_mask:0xf bank_mask:0xf
    v_and_b32_dpp v45, v31, v13 quad_perm:[0,0,0,0] row_mask:0xf bank_mask:0xf
    v_and_b32_dpp v46, v33, v14 quad_perm:[3,3,3,3] row_mask:0xf bank_mask:0xf
    v_and_b32_dpp v47, v33, v15 quad_perm:[3,3,3,3] row_mask:0xf bank_mask:0xf
    s_waitcnt vmcnt(15)
    v_mfma_f32_16x16x32_bf16 v[16:19], v[136:139], v[48:51], v[16:19]
    v_and_b32_dpp v50, v31, v14 quad_perm:[0,0,0,0] row_mask:0xf bank_mask:0xf
    v_and_b32_dpp v51, v31, v15 quad_perm:[0,0,0,0] row_mask:0xf bank_mask:0xf
    v_and_b32_dpp v48, v33, v12 quad_perm:[3,3,3,3] row_mask:0xf bank_mask:0xf
    v_and_b32_dpp v49, v33, v13 quad_perm:[3,3,3,3] row_mask:0xf bank_mask:0xf
    s_waitcnt vmcnt(14)
    v_mfma_f32_16x16x32_bf16 v[16:19], v[140:143], v[44:47], v[16:19]
    v_and_b32_dpp v44, v30, v12 quad_perm:[1,1,1,1] row_mask:0xf bank_mask:0xf
    v_and_b32_dpp v45, v30, v13 quad_perm:[1,1,1,1] row_mask:0xf bank_mask:0xf
    v_and_b32_dpp v46, v32, v14 quad_perm:[2,2,2,2] row_mask:0xf bank_mask:0xf
    v_and_b32_dpp v47, v32, v15 quad_perm:[2,2,2,2] row_mask:0xf bank_mask:0xf
    s_waitcnt vmcnt(13)
    v_mfma_f32_16x16x32_bf16 v[16:19], v[144:147], v[48:51], v[16:19]
    v_and_b32_dpp v50, v30, v14 quad_perm:[1,1,1,1] row_mask:0xf bank_mask:0xf
    v_and_b32_dpp v51, v30, v15 quad_perm:[1,1,1,1] row_mask:0xf bank_mask:0xf
    v_and_b32_dpp v48, v32, v12 quad_perm:[2,2,2,2] row_mask:0xf bank_mask:0xf
    v_and_b32_dpp v49, v32, v13 quad_perm:[2,2,2,2] row_mask:0xf bank_mask:0xf
    s_waitcnt vmcnt(12)
    v_mfma_f32_16x16x32_bf16 v[16:19], v[148:151], v[44:47], v[16:19]
    v_and_b32_dpp v44, v31, v12 quad_perm:[1,1,1,1] row_mask:0xf bank_mask:0xf
    v_and_b32_dpp v45, v31, v13 quad_perm:[1,1,1,1] row_mask:0xf bank_mask:0xf
    v_and_b32_dpp v46, v33, v14 quad_perm:[2,2,2,2] row_mask:0xf bank_mask:0xf
    v_and_b32_dpp v47, v33, v15 quad_perm:[2,2,2,2] row_mask:0xf bank_mask:0xf
    s_waitcnt vmcnt(11)
    v_mfma_f32_16x16x32_bf16 v[16:19], v[152:155], v[48:51], v[16:19]
    v_and_b32_dpp v50, v31, v14 quad_perm:[1,1,1,1] row_mask:0xf bank_mask:0xf
    v_and_b32_dpp v51, v31, v15 quad_perm:[1,1,1,1] row_mask:0xf bank_mask:0xf
    v_and_b32_dpp v48, v33, v12 quad_perm:[2,2,2,2] row_mask:0xf bank_mask:0xf
    v_and_b32_dpp v49, v33, v13 quad_perm:[2,2,2,2] row_mask:0xf bank_mask:0xf
    s_waitcnt vmcnt(10)
    v_mfma_f32_16x16x32_bf16 v[16:19], v[156:159], v[44:47], v[16:19]
    v_and_b32_dpp v44, v30, v12 quad_perm:[2,2,2,2] row_mask:0xf bank_mask:0xf
    v_and_b32_dpp v45, v30, v13 quad_perm:[2,2,2,2] row_mask:0xf bank_mask:0xf
    v_and_b32_dpp v46, v32, v14 quad_perm:[1,1,1,1] row_mask:0xf bank_mask:0xf
    v_and_b32_dpp v47, v32, v15 quad_perm:[1,1,1,1] row_mask:0xf bank_mask:0xf
    s_waitcnt vmcnt(9)
    v_mfma_f32_16x16x32_bf16 v[16:19], v[160:163], v[48:51], v[16:19]
    v_and_b32_dpp v50, v30, v14 quad_perm:[2,2,2,2] row_mask:0xf bank_mask:0xf
    v_and_b32_dpp v51, v30, v15 quad_perm:[2,2,2,2] row_mask:0xf bank_mask:0xf
    v_and_b32_dpp v48, v32, v12 quad_perm:[1,1,1,1] row_mask:0xf bank_mask:0xf
    v_and_b32_dpp v49, v32, v13 quad_perm:[1,1,1,1] row_mask:0xf bank_mask:0xf
    s_waitcnt vmcnt(8)
    v_mfma_f32_16x16x32_bf16 v[16:19], v[164:167], v[44:47], v[16:19]
    v_and_b32_dpp v44, v31, v12 quad_perm:[2,2,2,2] row_mask:0xf bank_mask:0xf
    v_and_b32_dpp v45, v31, v13 quad_perm:[2,2,2,2] row_mask:0xf bank_mask:0xf
    v_and_b32_dpp v46, v33, v14 quad_perm:[1,1,1,1] row_mask:0xf bank_mask:0xf
    v_and_b32_dpp v47, v33, v15 quad_perm:[1,1,1,1] row_mask:0xf bank_mask:0xf
    s_waitcnt vmcnt(7)
    v_mfma_f32_16x16x32_bf16 v[16:19], v[168:171], v[48:51], v[16:19]
    v_and_b32_dpp v50, v31, v14 quad_perm:[2,2,2,2] row_mask:0xf bank_mask:0xf
    v_and_b32_dpp v51, v31, v15 quad_perm:[2,2,2,2] row_mask:0xf bank_mask:0xf
    v_and_b32_dpp v48, v33, v12 quad_perm:[1,1,1,1] row_mask:0xf bank_mask:0xf
    v_and_b32_dpp v49, v33, v13 quad_perm:[1,1,1,1] row_mask:0xf bank_mask:0xf
    s_waitcnt vmcnt(6)
    v_mfma_f32_16x16x32_bf16 v[16:19], v[172:175], v[44:47], v[16:19]
    v_and_b32_dpp v44, v30, v12 quad_perm:[3,3,3,3] row_mask:0xf bank_mask:0xf
    v_and_b32_dpp v45, v30, v13 quad_perm:[3,3,3,3] row_mask:0xf bank_mask:0xf
    v_and_b32_dpp v46, v32, v14 quad_perm:[0,0,0,0] row_mask:0xf bank_mask:0xf
    v_and_b32_dpp v47, v32, v15 quad_perm:[0,0,0,0] row_mask:0xf bank_mask:0xf
    s_waitcnt vmcnt(5)
    v_mfma_f32_16x16x32_bf16 v[16:19], v[176:179], v[48:51], v[16:19]
    v_and_b32_dpp v50, v30, v14 quad_perm:[3,3,3,3] row_mask:0xf bank_mask:0xf
    v_and_b32_dpp v51, v30, v15 quad_perm:[3,3,3,3] row_mask:0xf bank_mask:0xf
    v_and_b32_dpp v48, v32, v12 quad_perm:[0,0,0,0] row_mask:0xf bank_mask:0xf
    v_and_b32_dpp v49, v32, v13 quad_perm:[0,0,0,0] row_mask:0xf bank_mask:0xf
    s_waitcnt vmcnt(4)
    v_mfma_f32_16x16x32_bf16 v[16:19], v[180:183], v[44:47], v[16:19]
    v_and_b32_dpp v44, v31, v12 quad_perm:[3,3,3,3] row_mask:0xf bank_mask:0xf
    v_and_b32_dpp v45, v31, v13 quad_perm:[3,3,3,3] row_mask:0xf bank_mask:0xf
    v_and_b32_dpp v46, v33, v14 quad_perm:[0,0,0,0] row_mask:0xf bank_mask:0xf
    v_and_b32_dpp v47, v33, v15 quad_perm:[0,0,0,0] row_mask:0xf bank_mask:0xf
    s_waitcnt vmcnt(3)
    v_mfma_f32_16x16x32_bf16 v[16:19], v[184:187], v[48:51], v[16:19]
    v_and_b32_dpp v50, v31, v14 quad_perm:[3,3,3,3] row_mask:0xf bank_mask:0xf
    v_and_b32_dpp v51, v31, v15 quad_perm:[3,3,3,3] row_mask:0xf bank_mask:0xf
    v_and_b32_dpp v48, v33, v12 quad_perm:[0,0,0,0] row_mask:0xf bank_mask:0xf
    v_and_b32_dpp v49, v33, v13 quad_perm:[0,0,0,0] row_mask:0xf bank_mask:0xf
    s_waitcnt vmcnt(2)
    v_mfma_f32_16x16x32_bf16 v[16:19], v[188:191], v[44:47], v[16:19]
    s_waitcnt vmcnt(1)
    v_mfma_f32_16x16x32_bf16 v[16:19], v[192:195], v[48:51], v[16:19]
    s_nop 7
    buffer_store_dwordx4 v[16:19], v58, s[20:23], 0 offen sc1
    s_endpgm
L_switch:
    s_mov_b32 s26, 0
    s_mov_b32 s8, s36
    s_mov_b32 s9, s37
    v_mov_b32 v1, v60
    s_waitcnt vmcnt(10)
    s_branch L_kbody
L_wait:
    v_mov_b32 v3, 0
    s_mov_b32 s32, 4194304
L_wait1:
    global_load_dword v56, v3, s[44:45] sc1
    s_sub_u32 s32, s32, 1
    s_cbranch_scc1 L_end
    s_waitcnt vmcnt(0)
    v_cmp_eq_u32 vcc, 0, v56
    s_cbranch_vccnz L_wait1
    s_branch L_ready
L_comb:
    s_cmp_ge_u32 s2, 272
    s_cbranch_scc1 L_end
    s_load_dwordx2 s[28:29], s[0:1], 48
    s_load_dwordx4 s[44:47], s[0:1], 56
    s_sub_u32 s3, s2, 256
    s_mov_b32 s33, 0xffa5a5a5
    s_lshl_b32 s24, s3, 14
    s_add_u32 s25, s24, 0x1000
    s_add_u32 s26, s24, 0x2000
    s_add_u32 s27, s24, 0x3000
    s_lshl_b32 s5, s3, 8
    s_add_u32 s5, s5, 262144
    v_lshrrev_b32 v1, 5, v0
    v_bfe_u32 v2, v0, 3, 2
    v_and_b32 v3, 7, v0
    v_lshlrev_b32 v4, 4, v3
    v_lshl_or_b32 v4, v1, 7, v4
    v_lshl_or_b32 v4, v2, 8, v4
    v_lshlrev_b32 v6, 1, v3
    v_lshl_or_b32 v6, v2, 6, v6
    v_lshl_or_b32 v6, v1, 8, v6
    v_and_b32 v3, 15, v0
    v_lshlrev_b32 v3, 4, v3
    v_lshl_or_b32 v3, v1, 3, v3
    v_add_u32 v5, s5, v3
    v_mov_b32 v8, s33
    v_mov_b32 v9, s33
    s_lshl_b32 s4, s3, 2
    v_mov_b32 v2, s4
    v_mov_b32 v3, 1
    s_mov_b32 s22, 266240
    s_mov_b32 s23, 0x20000
    s_mov_b32 s42, 512
    s_mov_b32 s43, 0x20000
    s_mov_b32 s32, 4194304
    s_lshl_b32 s4, s3, 9
    s_waitcnt lgkmcnt(0)
    s_mov_b32 s20, s46
    s_mov_b32 s21, s47
    s_add_u32 s40, s28, s4
    s_addc_u32 s41, s29, 0
    buffer_store_dwordx2 v[8:9], v5, s[20:23], 0 offen sc1
    s_waitcnt vmcnt(0)
    s_mov_b64 exec, 1
    global_store_dword v2, v3, s[44:45] sc1
    s_mov_b64 exec, -1
L_spin:
    buffer_load_dwordx2 v[12:13], v5, s[20:23], 0 offen sc1
    s_sub_u32 s32, s32, 1
    s_cbranch_scc1 L_end
    s_waitcnt vmcnt(0)
    v_cmp_eq_u32 vcc, s33, v12
    v_cmp_eq_u32 s[4:5], s33, v13
    s_or_b64 vcc, vcc, s[4:5]
    s_cbranch_vccnz L_spin
    s_mov_b32 s34, 0
L_poll:
    s_mov_b64 exec, -1
    buffer_load_dwordx4 v[20:23], v4, s[20:23], s24 offen offset:0 sc1
    buffer_load_dwordx4 v[24:27], v4, s[20:23], s24 offen offset:1024 sc1
    buffer_load_dwordx4 v[28:31], v4, s[20:23], s24 offen offset:2048 sc1
    buffer_load_dwordx4 v[32:35], v4, s[20:23], s24 offen offset:3072 sc1
    buffer_load_dwordx4 v[36:39], v4, s[20:23], s25 offen offset:0 sc1
    buffer_load_dwordx4 v[40:43], v4, s[20:23], s25 offen offset:1024 sc1
    buffer_load_dwordx4 v[44:47], v4, s[20:23], s25 offen offset:2048 sc1
    buffer_load_dwordx4 v[48:51], v4, s[20:23], s25 offen offset:3072 sc1
    buffer_load_dwordx4 v[52:55], v4, s[20:23], s26 offen offset:0 sc1
    buffer_load_dwordx4 v[56:59], v4, s[20:23], s26 offen offset:1024 sc1
    buffer_load_dwordx4 v[60:63], v4, s[20:23], s26 offen offset:2048 sc1
    buffer_load_dwordx4 v[64:67], v4, s[20:23], s26 offen offset:3072 sc1
    buffer_load_dwordx4 v[68:71], v4, s[20:23], s27 offen offset:0 sc1
    buffer_load_dwordx4 v[72:75], v4, s[20:23], s27 offen offset:1024 sc1
    buffer_load_dwordx4 v[76:79], v4, s[20:23], s27 offen offset:2048 sc1
    buffer_load_dwordx4 v[80:83], v4, s[20:23], s27 offen offset:3072 sc1
    s_sub_u32 s32, s32, 1
    s_cbranch_scc1 L_end
    s_cmp_lg_u32 s34, 0
    s_cbranch_scc1 L_sum
    v_mov_b32 v14, v12
    s_nop 1
    v_max_f32_dpp v14, v14, v14 quad_perm:[1,0,3,2] row_mask:0xf bank_mask:0xf
    s_nop 1
    v_max_f32_dpp v14, v14, v14 quad_perm:[2,3,0,1] row_mask:0xf bank_mask:0xf
    s_nop 1
    v_max_f32_dpp v14, v14, v14 row_half_mirror row_mask:0xf bank_mask:0xf
    s_nop 1
    v_max_f32_dpp v14, v14, v14 row_mirror row_mask:0xf bank_mask:0xf
    v_sub_f32 v14, v12, v14
    v_exp_f32 v14, v14
    s_nop 0
    v_mul_f32 v15, v14, v13
    s_nop 1
    v_add_f32_dpp v15, v15, v15 quad_perm:[1,0,3,2] row_mask:0xf bank_mask:0xf
    s_nop 1
    v_add_f32_dpp v15, v15, v15 quad_perm:[2,3,0,1] row_mask:0xf bank_mask:0xf
    s_nop 1
    v_add_f32_dpp v15, v15, v15 row_half_mirror row_mask:0xf bank_mask:0xf
    s_nop 1
    v_add_f32_dpp v15, v15, v15 row_mirror row_mask:0xf bank_mask:0xf
    v_rcp_f32 v15, v15
    s_nop 0
    v_mul_f32 v14, v14, v15
    s_nop 0
L_sum:
    s_waitcnt vmcnt(15)
    v_mul_f32_dpp v16, v14, v20 row_newbcast:0 row_mask:0xf bank_mask:0xf
    v_mul_f32_dpp v17, v14, v21 row_newbcast:0 row_mask:0xf bank_mask:0xf
    v_mul_f32_dpp v18, v14, v22 row_newbcast:0 row_mask:0xf bank_mask:0xf
    v_mul_f32_dpp v19, v14, v23 row_newbcast:0 row_mask:0xf bank_mask:0xf
    s_waitcnt vmcnt(14)
    v_fmac_f32_dpp v16, v14, v24 row_newbcast:1 row_mask:0xf bank_mask:0xf
    v_fmac_f32_dpp v17, v14, v25 row_newbcast:1 row_mask:0xf bank_mask:0xf
    v_fmac_f32_dpp v18, v14, v26 row_newbcast:1 row_mask:0xf bank_mask:0xf
    v_fmac_f32_dpp v19, v14, v27 row_newbcast:1 row_mask:0xf bank_mask:0xf
    s_waitcnt vmcnt(13)
    v_fmac_f32_dpp v16, v14, v28 row_newbcast:2 row_mask:0xf bank_mask:0xf
    v_fmac_f32_dpp v17, v14, v29 row_newbcast:2 row_mask:0xf bank_mask:0xf
    v_fmac_f32_dpp v18, v14, v30 row_newbcast:2 row_mask:0xf bank_mask:0xf
    v_fmac_f32_dpp v19, v14, v31 row_newbcast:2 row_mask:0xf bank_mask:0xf
    s_waitcnt vmcnt(12)
    v_fmac_f32_dpp v16, v14, v32 row_newbcast:3 row_mask:0xf bank_mask:0xf
    v_fmac_f32_dpp v17, v14, v33 row_newbcast:3 row_mask:0xf bank_mask:0xf
    v_fmac_f32_dpp v18, v14, v34 row_newbcast:3 row_mask:0xf bank_mask:0xf
    v_fmac_f32_dpp v19, v14, v35 row_newbcast:3 row_mask:0xf bank_mask:0xf
    s_waitcnt vmcnt(11)
    v_fmac_f32_dpp v16, v14, v36 row_newbcast:4 row_mask:0xf bank_mask:0xf
    v_fmac_f32_dpp v17, v14, v37 row_newbcast:4 row_mask:0xf bank_mask:0xf
    v_fmac_f32_dpp v18, v14, v38 row_newbcast:4 row_mask:0xf bank_mask:0xf
    v_fmac_f32_dpp v19, v14, v39 row_newbcast:4 row_mask:0xf bank_mask:0xf
    s_waitcnt vmcnt(10)
    v_fmac_f32_dpp v16, v14, v40 row_newbcast:5 row_mask:0xf bank_mask:0xf
    v_fmac_f32_dpp v17, v14, v41 row_newbcast:5 row_mask:0xf bank_mask:0xf
    v_fmac_f32_dpp v18, v14, v42 row_newbcast:5 row_mask:0xf bank_mask:0xf
    v_fmac_f32_dpp v19, v14, v43 row_newbcast:5 row_mask:0xf bank_mask:0xf
    s_waitcnt vmcnt(9)
    v_fmac_f32_dpp v16, v14, v44 row_newbcast:6 row_mask:0xf bank_mask:0xf
    v_fmac_f32_dpp v17, v14, v45 row_newbcast:6 row_mask:0xf bank_mask:0xf
    v_fmac_f32_dpp v18, v14, v46 row_newbcast:6 row_mask:0xf bank_mask:0xf
    v_fmac_f32_dpp v19, v14, v47 row_newbcast:6 row_mask:0xf bank_mask:0xf
    s_waitcnt vmcnt(8)
    v_fmac_f32_dpp v16, v14, v48 row_newbcast:7 row_mask:0xf bank_mask:0xf
    v_fmac_f32_dpp v17, v14, v49 row_newbcast:7 row_mask:0xf bank_mask:0xf
    v_fmac_f32_dpp v18, v14, v50 row_newbcast:7 row_mask:0xf bank_mask:0xf
    v_fmac_f32_dpp v19, v14, v51 row_newbcast:7 row_mask:0xf bank_mask:0xf
    s_waitcnt vmcnt(7)
    v_fmac_f32_dpp v16, v14, v52 row_newbcast:8 row_mask:0xf bank_mask:0xf
    v_fmac_f32_dpp v17, v14, v53 row_newbcast:8 row_mask:0xf bank_mask:0xf
    v_fmac_f32_dpp v18, v14, v54 row_newbcast:8 row_mask:0xf bank_mask:0xf
    v_fmac_f32_dpp v19, v14, v55 row_newbcast:8 row_mask:0xf bank_mask:0xf
    s_waitcnt vmcnt(6)
    v_fmac_f32_dpp v16, v14, v56 row_newbcast:9 row_mask:0xf bank_mask:0xf
    v_fmac_f32_dpp v17, v14, v57 row_newbcast:9 row_mask:0xf bank_mask:0xf
    v_fmac_f32_dpp v18, v14, v58 row_newbcast:9 row_mask:0xf bank_mask:0xf
    v_fmac_f32_dpp v19, v14, v59 row_newbcast:9 row_mask:0xf bank_mask:0xf
    s_waitcnt vmcnt(5)
    v_fmac_f32_dpp v16, v14, v60 row_newbcast:10 row_mask:0xf bank_mask:0xf
    v_fmac_f32_dpp v17, v14, v61 row_newbcast:10 row_mask:0xf bank_mask:0xf
    v_fmac_f32_dpp v18, v14, v62 row_newbcast:10 row_mask:0xf bank_mask:0xf
    v_fmac_f32_dpp v19, v14, v63 row_newbcast:10 row_mask:0xf bank_mask:0xf
    s_waitcnt vmcnt(4)
    v_fmac_f32_dpp v16, v14, v64 row_newbcast:11 row_mask:0xf bank_mask:0xf
    v_fmac_f32_dpp v17, v14, v65 row_newbcast:11 row_mask:0xf bank_mask:0xf
    v_fmac_f32_dpp v18, v14, v66 row_newbcast:11 row_mask:0xf bank_mask:0xf
    v_fmac_f32_dpp v19, v14, v67 row_newbcast:11 row_mask:0xf bank_mask:0xf
    s_waitcnt vmcnt(3)
    v_fmac_f32_dpp v16, v14, v68 row_newbcast:12 row_mask:0xf bank_mask:0xf
    v_fmac_f32_dpp v17, v14, v69 row_newbcast:12 row_mask:0xf bank_mask:0xf
    v_fmac_f32_dpp v18, v14, v70 row_newbcast:12 row_mask:0xf bank_mask:0xf
    v_fmac_f32_dpp v19, v14, v71 row_newbcast:12 row_mask:0xf bank_mask:0xf
    s_waitcnt vmcnt(2)
    v_fmac_f32_dpp v16, v14, v72 row_newbcast:13 row_mask:0xf bank_mask:0xf
    v_fmac_f32_dpp v17, v14, v73 row_newbcast:13 row_mask:0xf bank_mask:0xf
    v_fmac_f32_dpp v18, v14, v74 row_newbcast:13 row_mask:0xf bank_mask:0xf
    v_fmac_f32_dpp v19, v14, v75 row_newbcast:13 row_mask:0xf bank_mask:0xf
    s_waitcnt vmcnt(1)
    v_fmac_f32_dpp v16, v14, v76 row_newbcast:14 row_mask:0xf bank_mask:0xf
    v_fmac_f32_dpp v17, v14, v77 row_newbcast:14 row_mask:0xf bank_mask:0xf
    v_fmac_f32_dpp v18, v14, v78 row_newbcast:14 row_mask:0xf bank_mask:0xf
    v_fmac_f32_dpp v19, v14, v79 row_newbcast:14 row_mask:0xf bank_mask:0xf
    s_waitcnt vmcnt(0)
    v_fmac_f32_dpp v16, v14, v80 row_newbcast:15 row_mask:0xf bank_mask:0xf
    v_fmac_f32_dpp v17, v14, v81 row_newbcast:15 row_mask:0xf bank_mask:0xf
    v_fmac_f32_dpp v18, v14, v82 row_newbcast:15 row_mask:0xf bank_mask:0xf
    v_fmac_f32_dpp v19, v14, v83 row_newbcast:15 row_mask:0xf bank_mask:0xf
    v_cmp_u_f32 vcc, v16, v17
    v_cmp_u_f32 s[4:5], v18, v19
    v_cvt_pk_bf16_f32 v16, v16, v17
    v_cvt_pk_bf16_f32 v18, v18, v19
    s_or_b64 vcc, vcc, s[4:5]
    s_cbranch_vccnz L_exact
L_out:
    buffer_store_short v16, v6, s[40:43], 0 offen
    buffer_store_short_d16_hi v16, v6, s[40:43], 0 offen offset:16
    buffer_store_short v18, v6, s[40:43], 0 offen offset:32
    buffer_store_short_d16_hi v18, v6, s[40:43], 0 offen offset:48
    s_endpgm
L_exact:
    s_add_u32 s34, s34, 1
    s_and_b32 s4, s34, 3
    s_cbranch_scc1 L_poll
    v_cmpx_ne_u32 vcc, s33, v20
    v_cmpx_ne_u32 vcc, s33, v21
    v_cmpx_ne_u32 vcc, s33, v22
    v_cmpx_ne_u32 vcc, s33, v23
    v_cmpx_ne_u32 vcc, s33, v24
    v_cmpx_ne_u32 vcc, s33, v25
    v_cmpx_ne_u32 vcc, s33, v26
    v_cmpx_ne_u32 vcc, s33, v27
    v_cmpx_ne_u32 vcc, s33, v28
    v_cmpx_ne_u32 vcc, s33, v29
    v_cmpx_ne_u32 vcc, s33, v30
    v_cmpx_ne_u32 vcc, s33, v31
    v_cmpx_ne_u32 vcc, s33, v32
    v_cmpx_ne_u32 vcc, s33, v33
    v_cmpx_ne_u32 vcc, s33, v34
    v_cmpx_ne_u32 vcc, s33, v35
    v_cmpx_ne_u32 vcc, s33, v36
    v_cmpx_ne_u32 vcc, s33, v37
    v_cmpx_ne_u32 vcc, s33, v38
    v_cmpx_ne_u32 vcc, s33, v39
    v_cmpx_ne_u32 vcc, s33, v40
    v_cmpx_ne_u32 vcc, s33, v41
    v_cmpx_ne_u32 vcc, s33, v42
    v_cmpx_ne_u32 vcc, s33, v43
    v_cmpx_ne_u32 vcc, s33, v44
    v_cmpx_ne_u32 vcc, s33, v45
    v_cmpx_ne_u32 vcc, s33, v46
    v_cmpx_ne_u32 vcc, s33, v47
    v_cmpx_ne_u32 vcc, s33, v48
    v_cmpx_ne_u32 vcc, s33, v49
    v_cmpx_ne_u32 vcc, s33, v50
    v_cmpx_ne_u32 vcc, s33, v51
    v_cmpx_ne_u32 vcc, s33, v52
    v_cmpx_ne_u32 vcc, s33, v53
    v_cmpx_ne_u32 vcc, s33, v54
    v_cmpx_ne_u32 vcc, s33, v55
    v_cmpx_ne_u32 vcc, s33, v56
    v_cmpx_ne_u32 vcc, s33, v57
    v_cmpx_ne_u32 vcc, s33, v58
    v_cmpx_ne_u32 vcc, s33, v59
    v_cmpx_ne_u32 vcc, s33, v60
    v_cmpx_ne_u32 vcc, s33, v61
    v_cmpx_ne_u32 vcc, s33, v62
    v_cmpx_ne_u32 vcc, s33, v63
    v_cmpx_ne_u32 vcc, s33, v64
    v_cmpx_ne_u32 vcc, s33, v65
    v_cmpx_ne_u32 vcc, s33, v66
    v_cmpx_ne_u32 vcc, s33, v67
    v_cmpx_ne_u32 vcc, s33, v68
    v_cmpx_ne_u32 vcc, s33, v69
    v_cmpx_ne_u32 vcc, s33, v70
    v_cmpx_ne_u32 vcc, s33, v71
    v_cmpx_ne_u32 vcc, s33, v72
    v_cmpx_ne_u32 vcc, s33, v73
    v_cmpx_ne_u32 vcc, s33, v74
    v_cmpx_ne_u32 vcc, s33, v75
    v_cmpx_ne_u32 vcc, s33, v76
    v_cmpx_ne_u32 vcc, s33, v77
    v_cmpx_ne_u32 vcc, s33, v78
    v_cmpx_ne_u32 vcc, s33, v79
    v_cmpx_ne_u32 vcc, s33, v80
    v_cmpx_ne_u32 vcc, s33, v81
    v_cmpx_ne_u32 vcc, s33, v82
    v_cmpx_ne_u32 vcc, s33, v83
    s_cmp_eq_u64 vcc, -1
    s_cbranch_scc0 L_poll
    s_branch L_out
L_end:
    s_endpgm
.section .rodata,"a"
.p2align 6
.amdhsa_kernel standalone__tree_speculative_verify_tree_attention_over_candidate_token_tree__decode_kernel
  .amdhsa_next_free_vgpr 196
  .amdhsa_next_free_sgpr 64
  .amdhsa_accum_offset 196
  .amdhsa_group_segment_fixed_size 0
  .amdhsa_kernarg_size 72
  .amdhsa_user_sgpr_count 2
  .amdhsa_user_sgpr_kernarg_segment_ptr 1
  .amdhsa_system_sgpr_workgroup_id_x 1
.end_amdhsa_kernel
```
